```python
import torch

def _softmax(x, axis=-1):
    return torch.softmax(x, dim=axis)
def _gelu(x):
    return torch.nn.functional.gelu(x, approximate="tanh")
def _silu(x):
    return torch.nn.functional.silu(x)
def _sigmoid(x):
    return torch.sigmoid(x)
def _layernorm(x, axis=-1, eps=1e-5):
    m = x.mean(dim=axis, keepdim=True)
    v = x.var(dim=axis, keepdim=True, unbiased=False)
    return (x - m) / torch.sqrt(v + eps)
def _scatter_add(tgt, idx, src, axis=0):
    return tgt.clone().index_add_(axis, idx, src)
def _segment_sum(src, seg, n):
    out = torch.zeros((n,) + src.shape[1:], dtype=src.dtype)
    return out.index_add_(0, seg, src)
def _pad(x, pw):
    flat = tuple(v for pair in reversed(pw) for v in pair)
    return torch.nn.functional.pad(x, flat)

kernel_name = 'recurrent_scan__spectral_gfnet__dense_activation_relu__prompt'

def setup_inputs():

    _w = (lambda a: (lambda t: t.to(torch.bfloat16) if t.is_floating_point() else t)(torch.as_tensor(a)))
    def _A_setup():
        B, S, D = 1, 2048, 512
        Df = D // 2 + 1
        return {
            "x": _w((lambda *s: torch.randn(*s, dtype=torch.bfloat16) * 0.05)(B, S, D)),
            "w_r": _w((lambda *s: torch.randn(*s, dtype=torch.bfloat16) * 0.1)(S, Df) * 0.02),
            "w_i": _w((lambda *s: torch.randn(*s, dtype=torch.bfloat16) * 0.1)(S, Df) * 0.02),
        }
    _A_in = _A_setup()

    def _B_setup():
        B, S, D, Dff = 1, 2048, 512, 1792
        return {
            "x": _w((lambda *s: torch.randn(*s, dtype=torch.bfloat16) * 0.05)(B, S, D)),
            "w1": _w((lambda *s: torch.randn(*s, dtype=torch.bfloat16) * 0.05)(D, Dff)),
            "w2": _w((lambda *s: torch.randn(*s, dtype=torch.bfloat16) * 0.05)(Dff, D)),
        }
    _B_in = _B_setup()

    return {
        "A_x": _A_in["x"],
        "A_w_r": _A_in["w_r"],
        "A_w_i": _A_in["w_i"],
        "B_x": _B_in["x"],
        "B_w1": _B_in["w1"],
        "B_w2": _B_in["w2"],
    }

def reference(A_x, A_w_r, A_w_i, B_x, B_w1, B_w2):
    def _A_ref(x, w_r, w_i):
        B, S, D = x.shape
        X = (lambda x, axes=(-2,-1): torch.fft.rfft2(x.float(), dim=axes))(x, axes=(-2, -1))
        W = w_r + 1j * w_i
        X = X * W
        y = (lambda x, s, axes=(-2,-1): torch.fft.irfft2(x, s=s, dim=axes).to(torch.bfloat16))(X, (S, D), axes=(-2, -1))
        return y

    def _B_ref(x, w1, w2):
        h = torch.einsum("bsd,df->bsf", x, w1)
        zero = torch.zeros_like(h)
        h = torch.maximum(h, zero)
        return torch.einsum("bsf,fd->bsd", h, w2)

    x = A_x
    xn = _layernorm(x, axis=-1)
    s = _A_ref(xn, A_w_r, A_w_i)
    g = _silu(_B_ref(xn, B_w1, B_w2))
    return x + s * g
```

```asm
; @launch grid=(256,1,1) block=(512,1,1) lds=163840
.amdgcn_target "amdgcn-amd-amdhsa--gfx950"
.text
.globl recurrent_scan__spectral_gfnet__dense_activation_relu__prompt_kernel
.p2align 8
.type recurrent_scan__spectral_gfnet__dense_activation_relu__prompt_kernel,@function
recurrent_scan__spectral_gfnet__dense_activation_relu__prompt_kernel:
    s_cmp_ge_u32 s2, 256
    s_cbranch_scc1 L_done
    s_load_dwordx2 s[12:13], s[0:1], 0
    s_load_dwordx2 s[24:25], s[0:1], 32
    s_load_dwordx2 s[36:37], s[0:1], 64
    s_load_dwordx2 s[16:17], s[0:1], 8
    s_load_dwordx2 s[20:21], s[0:1], 16
    s_load_dwordx2 s[28:29], s[0:1], 40
    s_load_dwordx2 s[32:33], s[0:1], 48
    v_lshrrev_b32 v19, 6, v0
    s_getpc_b64 s[44:45]
L_pc:
    s_andn2_b32 s43, s2, 7
    v_add_lshl_u32 v20, v19, s43, 7
    v_min_u32 v20, L_end-L_pc-4, v20
    v_mov_b32 v21, s45
    v_add_co_u32 v20, vcc, s44, v20
    v_readfirstlane_b32 s7, v19
    v_and_b32 v1, 63, v0
    v_addc_co_u32 v21, vcc, 0, v21, vcc
    global_load_dword v247, v[20:21], off
    s_mov_b32 s14, 0x200000
    s_mov_b32 s15, 0x00020000
    s_mov_b32 s18, 0x101000
    s_mov_b32 s19, 0x00020000
    s_mov_b32 s22, 0x101000
    s_mov_b32 s23, 0x00020000
    s_mov_b32 s26, 0x1c0000
    s_mov_b32 s27, 0x00020000
    s_mov_b32 s30, 0x1c0000
    s_mov_b32 s31, 0x00020000
    s_mov_b32 s34, 0x200000
    s_mov_b32 s35, 0x00020000
    s_mov_b32 s38, 0x1600000
    s_mov_b32 s39, 0x00020000
    v_and_b32 v3, 15, v0
    v_bfe_u32 v4, v0, 4, 2
    v_lshlrev_b32 v2, 4, v1
    v_mov_b32 v25, 0x26c00
    s_and_b32 s10, s2, 7
    s_lshr_b32 s11, s2, 6
    s_bfe_u32 s40, s2, 0x30003
    s_and_b32 s3, s7, 3
    s_lshr_b32 s4, s10, 1
    s_lshl2_add_u32 s4, s4, s11
    s_and_b32 s43, s10, 1
    s_lshl3_add_u32 s5, s43, s40
    s_lshl1_add_u32 s8, s11, s40
    s_add_u32 s8, s11, s40
    s_and_b32 s8, s8, 1
    s_lshl_b32 s8, s8, 2
    s_lshl2_add_u32 s42, s4, s3
    s_lshr_b32 s10, s4, 1
    s_and_b32 s46, s4, 1
    s_lshl1_add_u32 s11, s46, s43
    s_lshr_b32 s7, s7, 2
    s_cbranch_scc1 L_fft
    s_lshl_b32 s48, s46, 20
    s_lshl2_add_u32 s44, s10, s3
    s_lshl_b32 s44, s44, 10
    s_add_u32 s48, s48, s44
    v_lshrrev_b32 v10, 3, v1
    v_and_b32 v12, 7, v1
    v_xor_b32 v6, v12, v4
    v_lshlrev_b32 v6, 4, v6
    v_lshl_add_u32 v6, v10, 15, v6
    v_xor_b32 v7, 64, v6
    v_add_u32 v7, 0x40000, v7
    s_lshl_b32 s57, s3, 12
    s_lshl_b32 s58, s3, 11
    s_sub_u32 s6, s5, s43
    s_lshl_b32 s6, s6, 8
    s_cmp_eq_u32 s40, 7
    s_cselect_b32 s6, 0x8000000, s6
    s_waitcnt lgkmcnt(0)
    s_load_dword s9, s[36:37], 0x40000
    s_add_u32 m0, s57, 65536
    s_add_u32 s0, s8, 0
    s_and_b32 s0, s0, 7
    s_lshl_b32 s0, s0, 7
    s_add_u32 s0, s0, s48
    buffer_load_dwordx4 v6, s[12:15], s0 offen lds
    s_add_u32 m0, s57, 66560
    s_nop 0
    buffer_load_dwordx4 v7, s[12:15], s0 offen lds
    s_add_u32 m0, s57, 67584
    s_add_u32 s0, s0, 0x80000
    buffer_load_dwordx4 v6, s[12:15], s0 offen lds
    s_add_u32 m0, s57, 68608
    s_nop 0
    buffer_load_dwordx4 v7, s[12:15], s0 offen lds
    s_add_u32 m0, s57, 81920
    s_add_u32 s0, s8, 1
    s_and_b32 s0, s0, 7
    s_lshl_b32 s0, s0, 7
    s_add_u32 s0, s0, s48
    buffer_load_dwordx4 v6, s[12:15], s0 offen lds
    s_add_u32 m0, s57, 82944
    s_nop 0
    buffer_load_dwordx4 v7, s[12:15], s0 offen lds
    s_add_u32 m0, s57, 83968
    s_add_u32 s0, s0, 0x80000
    buffer_load_dwordx4 v6, s[12:15], s0 offen lds
    s_add_u32 m0, s57, 84992
    s_nop 0
    buffer_load_dwordx4 v7, s[12:15], s0 offen lds
    s_lshl2_add_u32 s43, s2, s3
    s_mul_i32 s43, s43, 1792
    v_lshlrev_b32 v19, 7, v1
    s_mov_b32 m0, 0x27800
    s_mov_b64 exec, 0x3fff
    buffer_load_dword v19, s[24:27], s43 offen lds
    s_mov_b64 exec, -1
    s_lshl_b32 s43, s3, 4
    v_add_u32 v11, s43, v10
    v_mul_u32_u24 v11, 3584, v11
    v_and_b32 v13, 1, v4
    v_lshlrev_b32 v13, 1, v13
    v_xor_b32 v13, v13, v12
    v_lshl_add_u32 v8, v13, 4, v11
    v_xor_b32 v13, 4, v13
    v_lshl_add_u32 v9, v13, 4, v11
    v_add_u32 v9, 28672, v9
    v_lshlrev_b32 v15, 13, v10
    v_lshl_add_u32 v15, v12, 4, v15
    s_lshl_b32 s43, s3, 1
    v_xor_b32 v14, s43, v12
    v_lshlrev_b32 v14, 4, v14
    v_lshl_add_u32 v14, v1, 7, v14
    v_add_u32 v14, 0x24000, v14
    v_xor_b32 v13, v10, v12
    v_lshlrev_b32 v13, 4, v13
    v_lshl_add_u32 v13, v10, 7, v13
    s_add_u32 s43, s58, 0x24000
    v_add_u32 v13, s43, v13
    v_lshlrev_b32 v19, 1, v4
    v_xor_b32 v19, v19, v12
    v_lshlrev_b32 v19, 4, v19
    v_lshl_add_u32 v24, v10, 10, v19
    v_lshrrev_b32 v19, 1, v3
    v_xor_b32 v19, v19, v4
    v_lshlrev_b32 v19, 4, v19
    v_lshl_add_u32 v19, v3, 7, v19
    s_lshl_b32 s43, s3, 12
    v_add_u32 v26, s43, v19
    v_xor_b32 v27, 64, v26
    v_add_u32 v28, 0x10000, v26
    v_add_u32 v29, 0x10000, v27
    v_mov_b32 v19, 0
    v_lshl_add_u32 v30, v3, 2, v25
    ds_write_b32 v30, v19
    v_lshrrev_b32 v19, 2, v3
    v_lshl_add_u32 v30, v4, 3, v19
    v_lshlrev_b32 v30, 7, v30
    v_and_b32 v31, 1, v3
    v_lshl_add_u32 v30, v31, 3, v30
    v_bfe_u32 v19, v3, 3, 1
    v_and_b32 v31, 1, v4
    v_lshl_or_b32 v19, v31, 1, v19
    v_lshlrev_b32 v19, 1, v19
    v_bfe_u32 v31, v3, 1, 1
    v_or_b32 v19, v19, v31
    v_lshl_add_u32 v30, v19, 4, v30
    v_add_u32 v30, 0x10000, v30
    v_xor_b32 v16, 0, v30
    v_xor_b32 v17, 32, v30
    v_xor_b32 v18, 64, v30
    v_xor_b32 v20, 96, v30
    v_lshlrev_b32 v99, 4, v4
    v_add_u32 v99, 0x26000, v99
    s_lshl_b32 s43, s3, 9
    s_add_u32 s43, s43, 0x26400
    v_lshl_add_u32 v96, v3, 2, s43
    s_mul_i32 s61, s42, 114688
    s_add_u32 s61, s61, 0x800000
    s_lshl4_add_u32 s59, s6, s61
    s_and_b32 s45, s2, 1
    s_lshl1_add_u32 s62, s4, s45
    s_lshl2_add_u32 s62, s62, s3
    s_lshl_b32 s62, s62, 7
    s_add_u32 s62, s62, 0x20000
    s_lshl2_add_u32 s60, s40, s62
    s_mul_i32 s43, s45, 7
    s_lshr_b32 s44, s2, 6
    s_lshl1_add_u32 s44, s44, s40
    s_and_b32 s44, s44, 7
    s_cmp_eq_u32 s44, 7
    s_cselect_b32 s44, 0, s44
    s_add_u32 s50, s44, s43
    s_add_u32 s44, s44, 1
    s_cmp_eq_u32 s44, 7
    s_cselect_b32 s44, 0, s44
    s_add_u32 s51, s44, s43
    s_add_u32 s44, s44, 1
    s_cmp_eq_u32 s44, 7
    s_cselect_b32 s44, 0, s44
    s_add_u32 s52, s44, s43
    s_add_u32 s44, s44, 1
    s_cmp_eq_u32 s44, 7
    s_cselect_b32 s44, 0, s44
    s_add_u32 s53, s44, s43
    s_add_u32 s44, s44, 1
    s_cmp_eq_u32 s44, 7
    s_cselect_b32 s44, 0, s44
    s_add_u32 s54, s44, s43
    s_add_u32 s44, s44, 1
    s_cmp_eq_u32 s44, 7
    s_cselect_b32 s44, 0, s44
    s_add_u32 s55, s44, s43
    s_add_u32 s44, s44, 1
    s_cmp_eq_u32 s44, 7
    s_cselect_b32 s44, 0, s44
    s_add_u32 s56, s44, s43
    s_lshl_b32 s63, s40, 7
    s_lshl_b32 s43, s3, 14
    s_add_u32 s63, s63, s43
    s_mul_i32 s43, s45, 57344
    v_add_u32 v104, s43, v2
    s_sub_u32 s43, 57344, s43
    v_add_u32 v105, s43, v2
    v_min_u32 v19, 6, v1
    v_lshlrev_b32 v106, 2, v19
    v_lshrrev_b32 v19, 2, v3
    v_lshl_add_u32 v19, v4, 2, v19
    v_bfe_u32 v30, v19, 1, 2
    v_lshlrev_b32 v19, 7, v19
    v_and_b32 v31, 1, v3
    v_lshl_add_u32 v19, v31, 3, v19
    v_lshlrev_b32 v30, 1, v30
    v_bfe_u32 v31, v3, 1, 1
    v_or_b32 v30, v30, v31
    v_lshl_add_u32 v124, v30, 4, v19
    v_lshrrev_b32 v19, 3, v1
    v_and_b32 v30, 7, v1
    v_lshlrev_b32 v0, 15, v19
    v_lshl_add_u32 v0, v30, 4, v0
    v_lshlrev_b32 v30, 1, v30
    v_xor_b32 v30, v30, v19
    v_lshlrev_b32 v30, 4, v30
    v_lshl_add_u32 v30, v19, 8, v30
    s_lshl_b32 s43, s3, 12
    v_add_u32 v22, s43, v30
    v_xor_b32 v23, 16, v22
    v_xor_b32 v21, v4, v3
    v_lshlrev_b32 v21, 4, v21
    v_lshl_add_u32 v21, v3, 8, v21
    s_lshl_b32 s41, s11, 19
    s_lshl2_add_u32 s43, s10, s3
    s_lshl_b32 s43, s43, 10
    s_add_u32 s41, s41, s43
    s_lshl_b32 s43, s40, 7
    s_add_u32 s41, s41, s43
    v_add_u32 v30, 0x10000, v124
    v_xor_b32 v100, 0, v30
    v_xor_b32 v101, 32, v30
    v_xor_b32 v102, 64, v30
    v_xor_b32 v103, 96, v30
    s_add_u32 m0, s57, 98304
    s_add_u32 s0, s8, 2
    s_and_b32 s0, s0, 7
    s_lshl_b32 s0, s0, 7
    s_add_u32 s0, s0, s48
    buffer_load_dwordx4 v6, s[12:15], s0 offen lds
    s_add_u32 m0, s57, 99328
    s_nop 0
    buffer_load_dwordx4 v7, s[12:15], s0 offen lds
    s_add_u32 m0, s57, 100352
    s_add_u32 s0, s0, 0x80000
    buffer_load_dwordx4 v6, s[12:15], s0 offen lds
    s_add_u32 m0, s57, 101376
    s_nop 0
    buffer_load_dwordx4 v7, s[12:15], s0 offen lds
    s_add_u32 m0, s57, 114688
    s_add_u32 s0, s8, 3
    s_and_b32 s0, s0, 7
    s_lshl_b32 s0, s0, 7
    s_add_u32 s0, s0, s48
    buffer_load_dwordx4 v6, s[12:15], s0 offen lds
    s_add_u32 m0, s57, 115712
    s_nop 0
    buffer_load_dwordx4 v7, s[12:15], s0 offen lds
    s_add_u32 m0, s57, 116736
    s_add_u32 s0, s0, 0x80000
    buffer_load_dwordx4 v6, s[12:15], s0 offen lds
    s_add_u32 m0, s57, 117760
    s_nop 0
    buffer_load_dwordx4 v7, s[12:15], s0 offen lds
    s_waitcnt lgkmcnt(0)
    s_add_u32 s9, s9, 0x9e3779b9
    v_mov_b32 v5, s9
    s_lshr_b32 s4, s2, 5
    s_and_b32 s44, s2, 7
    s_lshl3_add_u32 s4, s44, s4
    s_and_b32 s7, s40, 3
    s_lshr_b32 s44, s4, 4
    s_lshl_b32 s44, s44, 4
    s_lshl1_add_u32 s44, s3, s44
    s_and_b32 s45, s4, 1
    s_lshl3_add_u32 s44, s45, s44
    s_bfe_u32 s45, s4, 0x30001
    s_lshl_b32 s45, s45, 8
    s_add_u32 s44, s44, s45
    s_mul_i32 s44, s44, 514
    s_lshl_b32 s47, s7, 7
    s_add_u32 s47, s47, s44
    v_lshlrev_b32 v11, 1, v1
    v_and_b32 v19, 3, v1
    v_mul_u32_u24 v19, 32896, v19
    v_bfe_u32 v30, v1, 2, 1
    v_mul_u32_u24 v30, 514, v30
    v_add_u32 v19, v19, v30
    s_cmp_eq_u32 s7, 3
    s_cselect_b32 s44, s44, 0x7f000000
    buffer_load_ushort v120, v19, s[16:19], s44 offen offset:512
    buffer_load_ushort v121, v19, s[20:23], s44 offen offset:512
    buffer_load_ushort v64, v11, s[16:19], s47 offen offset:0
    buffer_load_ushort v68, v11, s[20:23], s47 offen offset:0
    buffer_load_ushort v72, v11, s[16:19], s47 offen offset:514
    buffer_load_ushort v76, v11, s[20:23], s47 offen offset:514
    s_add_u32 s47, s47, 32896
    buffer_load_ushort v65, v11, s[16:19], s47 offen offset:0
    buffer_load_ushort v69, v11, s[20:23], s47 offen offset:0
    buffer_load_ushort v73, v11, s[16:19], s47 offen offset:514
    buffer_load_ushort v77, v11, s[20:23], s47 offen offset:514
    s_add_u32 s47, s47, 32896
    buffer_load_ushort v66, v11, s[16:19], s47 offen offset:0
    buffer_load_ushort v70, v11, s[20:23], s47 offen offset:0
    buffer_load_ushort v74, v11, s[16:19], s47 offen offset:514
    buffer_load_ushort v78, v11, s[20:23], s47 offen offset:514
    s_add_u32 s47, s47, 32896
    buffer_load_ushort v67, v11, s[16:19], s47 offen offset:0
    buffer_load_ushort v71, v11, s[20:23], s47 offen offset:0
    buffer_load_ushort v75, v11, s[16:19], s47 offen offset:514
    buffer_load_ushort v79, v11, s[20:23], s47 offen offset:514
    s_waitcnt vmcnt(27)
    s_barrier
    ds_read_b128 v[128:131], v28 offset:0
    ds_read_b128 v[136:139], v29 offset:0
    ds_read_b128 v[132:135], v28 offset:2048
    ds_read_b128 v[140:143], v29 offset:2048
    ds_read_b128 v[144:147], v28 offset:16384
    ds_read_b128 v[152:155], v29 offset:16384
    ds_read_b128 v[148:151], v28 offset:18432
    ds_read_b128 v[156:159], v29 offset:18432
    s_add_u32 m0, s57, 0
    s_add_u32 s0, s8, 4
    s_and_b32 s0, s0, 7
    s_lshl_b32 s0, s0, 7
    s_add_u32 s0, s0, s48
    buffer_load_dwordx4 v6, s[12:15], s0 offen lds
    s_add_u32 m0, s57, 1024
    s_nop 0
    buffer_load_dwordx4 v7, s[12:15], s0 offen lds
    s_add_u32 m0, s57, 2048
    s_add_u32 s0, s0, 0x80000
    buffer_load_dwordx4 v6, s[12:15], s0 offen lds
    s_add_u32 m0, s57, 3072
    s_nop 0
    buffer_load_dwordx4 v7, s[12:15], s0 offen lds
    s_add_u32 m0, s57, 16384
    s_add_u32 s0, s8, 5
    s_and_b32 s0, s0, 7
    s_lshl_b32 s0, s0, 7
    s_add_u32 s0, s0, s48
    buffer_load_dwordx4 v6, s[12:15], s0 offen lds
    s_add_u32 m0, s57, 17408
    s_nop 0
    buffer_load_dwordx4 v7, s[12:15], s0 offen lds
    s_add_u32 m0, s57, 18432
    s_add_u32 s0, s0, 0x80000
    buffer_load_dwordx4 v6, s[12:15], s0 offen lds
    s_add_u32 m0, s57, 19456
    s_nop 0
    buffer_load_dwordx4 v7, s[12:15], s0 offen lds
    s_waitcnt vmcnt(26)
    s_waitcnt lgkmcnt(0)
    s_barrier
    ds_read_b128 v[160:163], v28 offset:32768
    ds_read_b128 v[168:171], v29 offset:32768
    ds_read_b128 v[164:167], v28 offset:34816
    ds_read_b128 v[172:175], v29 offset:34816
    ds_read_b128 v[176:179], v28 offset:49152
    ds_read_b128 v[184:187], v29 offset:49152
    ds_read_b128 v[180:183], v28 offset:51200
    ds_read_b128 v[188:191], v29 offset:51200
    s_add_u32 m0, s57, 32768
    s_add_u32 s0, s8, 6
    s_and_b32 s0, s0, 7
    s_lshl_b32 s0, s0, 7
    s_add_u32 s0, s0, s48
    buffer_load_dwordx4 v6, s[12:15], s0 offen lds
    s_add_u32 m0, s57, 33792
    s_nop 0
    buffer_load_dwordx4 v7, s[12:15], s0 offen lds
    s_add_u32 m0, s57, 34816
    s_add_u32 s0, s0, 0x80000
    buffer_load_dwordx4 v6, s[12:15], s0 offen lds
    s_add_u32 m0, s57, 35840
    s_nop 0
    buffer_load_dwordx4 v7, s[12:15], s0 offen lds
    s_add_u32 m0, s57, 49152
    s_add_u32 s0, s8, 7
    s_and_b32 s0, s0, 7
    s_lshl_b32 s0, s0, 7
    s_add_u32 s0, s0, s48
    buffer_load_dwordx4 v6, s[12:15], s0 offen lds
    s_add_u32 m0, s57, 50176
    s_nop 0
    buffer_load_dwordx4 v7, s[12:15], s0 offen lds
    s_add_u32 m0, s57, 51200
    s_add_u32 s0, s0, 0x80000
    buffer_load_dwordx4 v6, s[12:15], s0 offen lds
    s_add_u32 m0, s57, 52224
    s_nop 0
    buffer_load_dwordx4 v7, s[12:15], s0 offen lds
    s_lshl2_add_u32 s43, s2, s3
    s_mul_i32 s43, s43, 1792
    v_lshlrev_b32 v19, 7, v1
    s_mov_b32 m0, 0x27800
    s_mov_b64 exec, 0x3fff
    buffer_load_dword v19, s[28:31], s43 offen lds
    s_mov_b64 exec, -1
    s_waitcnt vmcnt(17)
    v_lshl_or_b32 v64, v68, 16, v64
    v_lshl_or_b32 v65, v69, 16, v65
    v_lshl_or_b32 v66, v70, 16, v66
    v_lshl_or_b32 v67, v71, 16, v67
    v_lshl_or_b32 v72, v76, 16, v72
    v_lshl_or_b32 v73, v77, 16, v73
    v_lshl_or_b32 v74, v78, 16, v74
    v_lshl_or_b32 v75, v79, 16, v75
    v_lshl_or_b32 v120, v121, 16, v120
    ds_write_b128 v14, v[64:67]
    v_xor_b32 v19, 16, v14
    ds_write_b128 v19, v[72:75]
    s_lshl_b32 s43, s3, 5
    s_add_u32 s43, s43, 0x27000
    v_lshl_add_u32 v19, v1, 2, s43
    s_mov_b64 exec, 0xff
    ds_write_b32 v19, v120
    s_mov_b64 exec, -1
    s_waitcnt vmcnt(9)
    s_waitcnt lgkmcnt(0)
    s_barrier
    ds_read_b128 v[192:195], v26 offset:0
    ds_read_b128 v[200:203], v27 offset:0
    ds_read_b128 v[196:199], v26 offset:2048
    ds_read_b128 v[204:207], v27 offset:2048
    ds_read_b128 v[208:211], v26 offset:16384
    ds_read_b128 v[216:219], v27 offset:16384
    ds_read_b128 v[212:215], v26 offset:18432
    ds_read_b128 v[220:223], v27 offset:18432
    ds_read_b128 v[64:67], v13 offset:0
    ds_read_b128 v[68:71], v13 offset:1024
    v_add_u32 v19, 0x27000, v2
    ds_read_b128 v[72:75], v19
    s_add_u32 s1, s8, 0
    s_and_b32 s1, s1, 7
    s_mul_i32 s1, s1, 229376
    s_add_u32 m0, s58, 65664
    s_add_u32 s1, s1, s6
    s_add_u32 m0, s58, 65536
    s_nop 0
    buffer_load_dwordx4 v8, s[24:27], s1 offen lds
    s_add_u32 m0, s58, 66560
    s_nop 0
    buffer_load_dwordx4 v9, s[24:27], s1 offen lds
    s_add_u32 s1, s8, 1
    s_and_b32 s1, s1, 7
    s_mul_i32 s1, s1, 229376
    s_add_u32 m0, s58, 73856
    s_add_u32 s1, s1, s6
    s_add_u32 m0, s58, 73728
    s_nop 0
    buffer_load_dwordx4 v8, s[24:27], s1 offen lds
    s_add_u32 m0, s58, 74752
    s_nop 0
    buffer_load_dwordx4 v9, s[24:27], s1 offen lds
    s_add_u32 s1, s8, 2
    s_and_b32 s1, s1, 7
    s_mul_i32 s1, s1, 229376
    s_add_u32 m0, s58, 82048
    s_add_u32 s1, s1, s6
    s_add_u32 m0, s58, 81920
    s_nop 0
    buffer_load_dwordx4 v8, s[24:27], s1 offen lds
    s_add_u32 m0, s58, 82944
    s_nop 0
    buffer_load_dwordx4 v9, s[24:27], s1 offen lds
    s_add_u32 s1, s8, 3
    s_and_b32 s1, s1, 7
    s_mul_i32 s1, s1, 229376
    s_add_u32 m0, s58, 90240
    s_add_u32 s1, s1, s6
    s_add_u32 m0, s58, 90112
    s_nop 0
    buffer_load_dwordx4 v8, s[24:27], s1 offen lds
    s_add_u32 m0, s58, 91136
    s_nop 0
    buffer_load_dwordx4 v9, s[24:27], s1 offen lds
    s_waitcnt lgkmcnt(0)
    s_lshl2_add_u32 s45, s7, s3
    s_lshl_b32 s43, s45, 17
    s_lshl_b32 s44, s4, 7
    s_add_u32 s43, s43, s44
    s_add_u32 s43, s43, 0x400000
    buffer_store_dwordx4 v[64:67], v15, s[36:39], s43 offen sc1
    s_add_u32 s43, s43, 0x10000
    buffer_store_dwordx4 v[68:71], v15, s[36:39], s43 offen sc1
    s_add_u32 s44, s44, 0x600000
    s_cmp_eq_u32 s45, 12
    s_cselect_b32 s44, s44, 0x7f000000
    s_mov_b64 exec, 0xff
    buffer_store_dwordx4 v[72:75], v2, s[36:39], s44 offen sc1
    s_mov_b64 exec, -1
    s_waitcnt vmcnt(12)
    s_barrier
    ds_read_b128 v[224:227], v26 offset:32768
    ds_read_b128 v[232:235], v27 offset:32768
    ds_read_b128 v[228:231], v26 offset:34816
    ds_read_b128 v[236:239], v27 offset:34816
    ds_read_b128 v[240:243], v26 offset:49152
    ds_read_b128 v[248:251], v27 offset:49152
    ds_read_b128 v[244:247], v26 offset:51200
    ds_read_b128 v[252:255], v27 offset:51200
    s_add_u32 s1, s8, 4
    s_and_b32 s1, s1, 7
    s_mul_i32 s1, s1, 229376
    s_add_u32 m0, s58, 98432
    s_add_u32 s1, s1, s6
    s_add_u32 m0, s58, 98304
    s_nop 0
    buffer_load_dwordx4 v8, s[24:27], s1 offen lds
    s_add_u32 m0, s58, 99328
    s_nop 0
    buffer_load_dwordx4 v9, s[24:27], s1 offen lds
    s_add_u32 s1, s8, 5
    s_and_b32 s1, s1, 7
    s_mul_i32 s1, s1, 229376
    s_add_u32 m0, s58, 106624
    s_add_u32 s1, s1, s6
    s_add_u32 m0, s58, 106496
    s_nop 0
    buffer_load_dwordx4 v8, s[24:27], s1 offen lds
    s_add_u32 m0, s58, 107520
    s_nop 0
    buffer_load_dwordx4 v9, s[24:27], s1 offen lds
    s_add_u32 s1, s8, 6
    s_and_b32 s1, s1, 7
    s_mul_i32 s1, s1, 229376
    s_add_u32 m0, s58, 114816
    s_add_u32 s1, s1, s6
    s_add_u32 m0, s58, 114688
    s_nop 0
    buffer_load_dwordx4 v8, s[24:27], s1 offen lds
    s_add_u32 m0, s58, 115712
    s_nop 0
    buffer_load_dwordx4 v9, s[24:27], s1 offen lds
    s_add_u32 s1, s8, 7
    s_and_b32 s1, s1, 7
    s_mul_i32 s1, s1, 229376
    s_add_u32 m0, s58, 123008
    s_add_u32 s1, s1, s6
    s_add_u32 m0, s58, 122880
    s_nop 0
    buffer_load_dwordx4 v8, s[24:27], s1 offen lds
    s_add_u32 m0, s58, 123904
    s_nop 0
    buffer_load_dwordx4 v9, s[24:27], s1 offen lds
    s_waitcnt vmcnt(11)
    s_waitcnt lgkmcnt(0)
    s_barrier
    ds_read_b64_tr_b16 v[32:33], v16 offset:0
    ds_read_b64_tr_b16 v[34:35], v16 offset:512
    ds_read_b64_tr_b16 v[36:37], v17 offset:0
    ds_read_b64_tr_b16 v[38:39], v17 offset:512
    ds_read_b64_tr_b16 v[40:41], v18 offset:0
    ds_read_b64_tr_b16 v[42:43], v18 offset:512
    ds_read_b64_tr_b16 v[44:45], v20 offset:0
    ds_read_b64_tr_b16 v[46:47], v20 offset:512
    s_waitcnt lgkmcnt(0)
    v_mfma_f32_16x16x32_bf16 v[64:67], v[32:35], v[128:131], 0
    ds_read_b64_tr_b16 v[48:49], v16 offset:4096
    v_mfma_f32_16x16x32_bf16 v[68:71], v[32:35], v[132:135], 0
    ds_read_b64_tr_b16 v[50:51], v16 offset:4608
    v_mfma_f32_16x16x32_bf16 v[72:75], v[36:39], v[128:131], 0
    ds_read_b64_tr_b16 v[52:53], v17 offset:4096
    v_mfma_f32_16x16x32_bf16 v[76:79], v[36:39], v[132:135], 0
    ds_read_b64_tr_b16 v[54:55], v17 offset:4608
    s_add_u32 s1, s8, 0
    s_and_b32 s1, s1, 7
    s_mul_i32 s1, s1, 229376
    s_add_u32 m0, s58, 0
    s_add_u32 s1, s1, s6
    s_add_u32 s1, s1, 128
    buffer_load_dwordx4 v8, s[24:27], s1 offen lds
    v_mfma_f32_16x16x32_bf16 v[80:83], v[40:43], v[128:131], 0
    ds_read_b64_tr_b16 v[56:57], v18 offset:4096
    v_mfma_f32_16x16x32_bf16 v[84:87], v[40:43], v[132:135], 0
    ds_read_b64_tr_b16 v[58:59], v18 offset:4608
    v_mfma_f32_16x16x32_bf16 v[88:91], v[44:47], v[128:131], 0
    ds_read_b64_tr_b16 v[60:61], v20 offset:4096
    v_mfma_f32_16x16x32_bf16 v[92:95], v[44:47], v[132:135], 0
    ds_read_b64_tr_b16 v[62:63], v20 offset:4608
    s_add_u32 m0, s58, 1024
    s_nop 0
    buffer_load_dwordx4 v9, s[24:27], s1 offen lds
    s_waitcnt lgkmcnt(0)
    v_mfma_f32_16x16x32_bf16 v[64:67], v[48:51], v[136:139], v[64:67]
    ds_read_b64_tr_b16 v[32:33], v16 offset:8192
    v_mfma_f32_16x16x32_bf16 v[68:71], v[48:51], v[140:143], v[68:71]
    ds_read_b64_tr_b16 v[34:35], v16 offset:8704
    v_mfma_f32_16x16x32_bf16 v[72:75], v[52:55], v[136:139], v[72:75]
    ds_read_b64_tr_b16 v[36:37], v17 offset:8192
    v_mfma_f32_16x16x32_bf16 v[76:79], v[52:55], v[140:143], v[76:79]
    ds_read_b64_tr_b16 v[38:39], v17 offset:8704
    s_add_u32 s1, s8, 1
    s_and_b32 s1, s1, 7
    s_mul_i32 s1, s1, 229376
    s_add_u32 m0, s58, 8192
    s_add_u32 s1, s1, s6
    s_add_u32 s1, s1, 128
    buffer_load_dwordx4 v8, s[24:27], s1 offen lds
    v_mfma_f32_16x16x32_bf16 v[80:83], v[56:59], v[136:139], v[80:83]
    ds_read_b64_tr_b16 v[40:41], v18 offset:8192
    v_mfma_f32_16x16x32_bf16 v[84:87], v[56:59], v[140:143], v[84:87]
    ds_read_b64_tr_b16 v[42:43], v18 offset:8704
    v_mfma_f32_16x16x32_bf16 v[88:91], v[60:63], v[136:139], v[88:91]
    ds_read_b64_tr_b16 v[44:45], v20 offset:8192
    v_mfma_f32_16x16x32_bf16 v[92:95], v[60:63], v[140:143], v[92:95]
    ds_read_b64_tr_b16 v[46:47], v20 offset:8704
    s_add_u32 m0, s58, 9216
    s_nop 0
    buffer_load_dwordx4 v9, s[24:27], s1 offen lds
    s_waitcnt lgkmcnt(0)
    v_mfma_f32_16x16x32_bf16 v[64:67], v[32:35], v[144:147], v[64:67]
    ds_read_b64_tr_b16 v[48:49], v16 offset:12288
    v_mfma_f32_16x16x32_bf16 v[68:71], v[32:35], v[148:151], v[68:71]
    ds_read_b64_tr_b16 v[50:51], v16 offset:12800
    v_mfma_f32_16x16x32_bf16 v[72:75], v[36:39], v[144:147], v[72:75]
    ds_read_b64_tr_b16 v[52:53], v17 offset:12288
    v_mfma_f32_16x16x32_bf16 v[76:79], v[36:39], v[148:151], v[76:79]
    ds_read_b64_tr_b16 v[54:55], v17 offset:12800
    s_add_u32 s1, s8, 2
    s_and_b32 s1, s1, 7
    s_mul_i32 s1, s1, 229376
    s_add_u32 m0, s58, 16384
    s_add_u32 s1, s1, s6
    s_add_u32 s1, s1, 128
    buffer_load_dwordx4 v8, s[24:27], s1 offen lds
    v_mfma_f32_16x16x32_bf16 v[80:83], v[40:43], v[144:147], v[80:83]
    ds_read_b64_tr_b16 v[56:57], v18 offset:12288
    v_mfma_f32_16x16x32_bf16 v[84:87], v[40:43], v[148:151], v[84:87]
    ds_read_b64_tr_b16 v[58:59], v18 offset:12800
    v_mfma_f32_16x16x32_bf16 v[88:91], v[44:47], v[144:147], v[88:91]
    ds_read_b64_tr_b16 v[60:61], v20 offset:12288
    v_mfma_f32_16x16x32_bf16 v[92:95], v[44:47], v[148:151], v[92:95]
    ds_read_b64_tr_b16 v[62:63], v20 offset:12800
    s_add_u32 m0, s58, 17408
    s_nop 0
    buffer_load_dwordx4 v9, s[24:27], s1 offen lds
    s_lshl2_add_u32 s45, s7, s3
    s_lshr_b32 s44, s4, 2
    s_lshl4_add_u32 s43, s45, s44
    s_lshl_b32 s43, s43, 7
    s_and_b32 s44, s4, 3
    s_lshl2_add_u32 s43, s44, s43
    s_add_u32 s43, s43, 0x10000
    s_add_u32 s44, s43, 0x2000
    s_cmp_eq_u32 s45, 12
    s_cselect_b32 s44, s44, 0x7f000000
    s_waitcnt vmcnt(14)
    s_mov_b64 exec, 1
    buffer_store_dword v5, off, s[36:39], s43 sc1
    s_mov_b64 exec, -1
    s_mov_b64 exec, 1
    buffer_store_dword v5, off, s[36:39], s44 sc1
    s_mov_b64 exec, -1
    s_mov_b32 s7, 0
    s_waitcnt lgkmcnt(0)
    v_mfma_f32_16x16x32_bf16 v[64:67], v[48:51], v[152:155], v[64:67]
    ds_read_b64_tr_b16 v[32:33], v16 offset:16384
    v_mfma_f32_16x16x32_bf16 v[68:71], v[48:51], v[156:159], v[68:71]
    ds_read_b64_tr_b16 v[34:35], v16 offset:16896
    v_mfma_f32_16x16x32_bf16 v[72:75], v[52:55], v[152:155], v[72:75]
    ds_read_b64_tr_b16 v[36:37], v17 offset:16384
    v_mfma_f32_16x16x32_bf16 v[76:79], v[52:55], v[156:159], v[76:79]
    ds_read_b64_tr_b16 v[38:39], v17 offset:16896
    s_add_u32 s1, s8, 3
    s_and_b32 s1, s1, 7
    s_mul_i32 s1, s1, 229376
    s_add_u32 m0, s58, 24576
    s_add_u32 s1, s1, s6
    s_add_u32 s1, s1, 128
    buffer_load_dwordx4 v8, s[24:27], s1 offen lds
    v_mfma_f32_16x16x32_bf16 v[80:83], v[56:59], v[152:155], v[80:83]
    ds_read_b64_tr_b16 v[40:41], v18 offset:16384
    v_mfma_f32_16x16x32_bf16 v[84:87], v[56:59], v[156:159], v[84:87]
    ds_read_b64_tr_b16 v[42:43], v18 offset:16896
    v_mfma_f32_16x16x32_bf16 v[88:91], v[60:63], v[152:155], v[88:91]
    ds_read_b64_tr_b16 v[44:45], v20 offset:16384
    v_mfma_f32_16x16x32_bf16 v[92:95], v[60:63], v[156:159], v[92:95]
    ds_read_b64_tr_b16 v[46:47], v20 offset:16896
    s_add_u32 m0, s58, 25600
    s_nop 0
    buffer_load_dwordx4 v9, s[24:27], s1 offen lds
    s_waitcnt vmcnt(10)
    v_mov_b32 v19, 1
    s_mov_b64 exec, 1
    ds_add_u32 v25, v19 offset:0
    s_mov_b64 exec, -1
    s_waitcnt lgkmcnt(1)
    v_mfma_f32_16x16x32_bf16 v[64:67], v[32:35], v[160:163], v[64:67]
    ds_read_b64_tr_b16 v[48:49], v16 offset:20480
    v_mfma_f32_16x16x32_bf16 v[68:71], v[32:35], v[164:167], v[68:71]
    ds_read_b64_tr_b16 v[50:51], v16 offset:20992
    v_mfma_f32_16x16x32_bf16 v[72:75], v[36:39], v[160:163], v[72:75]
    ds_read_b64_tr_b16 v[52:53], v17 offset:20480
    v_mfma_f32_16x16x32_bf16 v[76:79], v[36:39], v[164:167], v[76:79]
    ds_read_b64_tr_b16 v[54:55], v17 offset:20992
    s_add_u32 s1, s8, 4
    s_and_b32 s1, s1, 7
    s_mul_i32 s1, s1, 229376
    s_add_u32 m0, s58, 32768
    s_add_u32 s1, s1, s6
    s_add_u32 s1, s1, 128
    buffer_load_dwordx4 v8, s[24:27], s1 offen lds
    v_mfma_f32_16x16x32_bf16 v[80:83], v[40:43], v[160:163], v[80:83]
    ds_read_b64_tr_b16 v[56:57], v18 offset:20480
    v_mfma_f32_16x16x32_bf16 v[84:87], v[40:43], v[164:167], v[84:87]
    ds_read_b64_tr_b16 v[58:59], v18 offset:20992
    v_mfma_f32_16x16x32_bf16 v[88:91], v[44:47], v[160:163], v[88:91]
    ds_read_b64_tr_b16 v[60:61], v20 offset:20480
    v_mfma_f32_16x16x32_bf16 v[92:95], v[44:47], v[164:167], v[92:95]
    ds_read_b64_tr_b16 v[62:63], v20 offset:20992
    s_add_u32 m0, s58, 33792
    s_nop 0
    buffer_load_dwordx4 v9, s[24:27], s1 offen lds
    s_waitcnt lgkmcnt(0)
    v_mfma_f32_16x16x32_bf16 v[64:67], v[48:51], v[168:171], v[64:67]
    ds_read_b64_tr_b16 v[32:33], v16 offset:24576
    v_mfma_f32_16x16x32_bf16 v[68:71], v[48:51], v[172:175], v[68:71]
    ds_read_b64_tr_b16 v[34:35], v16 offset:25088
    v_mfma_f32_16x16x32_bf16 v[72:75], v[52:55], v[168:171], v[72:75]
    ds_read_b64_tr_b16 v[36:37], v17 offset:24576
    v_mfma_f32_16x16x32_bf16 v[76:79], v[52:55], v[172:175], v[76:79]
    ds_read_b64_tr_b16 v[38:39], v17 offset:25088
    s_add_u32 s1, s8, 5
    s_and_b32 s1, s1, 7
    s_mul_i32 s1, s1, 229376
    s_add_u32 m0, s58, 40960
    s_add_u32 s1, s1, s6
    s_add_u32 s1, s1, 128
    buffer_load_dwordx4 v8, s[24:27], s1 offen lds
    v_mfma_f32_16x16x32_bf16 v[80:83], v[56:59], v[168:171], v[80:83]
    ds_read_b64_tr_b16 v[40:41], v18 offset:24576
    v_mfma_f32_16x16x32_bf16 v[84:87], v[56:59], v[172:175], v[84:87]
    ds_read_b64_tr_b16 v[42:43], v18 offset:25088
    v_mfma_f32_16x16x32_bf16 v[88:91], v[60:63], v[168:171], v[88:91]
    ds_read_b64_tr_b16 v[44:45], v20 offset:24576
    v_mfma_f32_16x16x32_bf16 v[92:95], v[60:63], v[172:175], v[92:95]
    ds_read_b64_tr_b16 v[46:47], v20 offset:25088
    s_add_u32 m0, s58, 41984
    s_nop 0
    buffer_load_dwordx4 v9, s[24:27], s1 offen lds
    s_waitcnt lgkmcnt(0)
    ds_read_b32 v107, v25 offset:0
    v_mfma_f32_16x16x32_bf16 v[64:67], v[32:35], v[176:179], v[64:67]
    ds_read_b64_tr_b16 v[48:49], v16 offset:28672
    v_mfma_f32_16x16x32_bf16 v[68:71], v[32:35], v[180:183], v[68:71]
    ds_read_b64_tr_b16 v[50:51], v16 offset:29184
    v_mfma_f32_16x16x32_bf16 v[72:75], v[36:39], v[176:179], v[72:75]
    ds_read_b64_tr_b16 v[52:53], v17 offset:28672
    v_mfma_f32_16x16x32_bf16 v[76:79], v[36:39], v[180:183], v[76:79]
    ds_read_b64_tr_b16 v[54:55], v17 offset:29184
    s_add_u32 s1, s8, 6
    s_and_b32 s1, s1, 7
    s_mul_i32 s1, s1, 229376
    s_add_u32 m0, s58, 49152
    s_add_u32 s1, s1, s6
    s_add_u32 s1, s1, 128
    buffer_load_dwordx4 v8, s[24:27], s1 offen lds
    v_mfma_f32_16x16x32_bf16 v[80:83], v[40:43], v[176:179], v[80:83]
    ds_read_b64_tr_b16 v[56:57], v18 offset:28672
    v_mfma_f32_16x16x32_bf16 v[84:87], v[40:43], v[180:183], v[84:87]
    ds_read_b64_tr_b16 v[58:59], v18 offset:29184
    v_mfma_f32_16x16x32_bf16 v[88:91], v[44:47], v[176:179], v[88:91]
    ds_read_b64_tr_b16 v[60:61], v20 offset:28672
    v_mfma_f32_16x16x32_bf16 v[92:95], v[44:47], v[180:183], v[92:95]
    ds_read_b64_tr_b16 v[62:63], v20 offset:29184
    s_add_u32 m0, s58, 50176
    s_nop 0
    buffer_load_dwordx4 v9, s[24:27], s1 offen lds
    s_waitcnt lgkmcnt(0)
    v_readfirstlane_b32 s43, v107
    s_cmp_lt_u32 s43, 4
    s_cbranch_scc1 L_gs0
L_gx0:
    v_mfma_f32_16x16x32_bf16 v[64:67], v[48:51], v[184:187], v[64:67]
    ds_read_b64_tr_b16 v[32:33], v16 offset:32768
    v_mfma_f32_16x16x32_bf16 v[68:71], v[48:51], v[188:191], v[68:71]
    ds_read_b64_tr_b16 v[34:35], v16 offset:33280
    v_mfma_f32_16x16x32_bf16 v[72:75], v[52:55], v[184:187], v[72:75]
    ds_read_b64_tr_b16 v[36:37], v17 offset:32768
    v_mfma_f32_16x16x32_bf16 v[76:79], v[52:55], v[188:191], v[76:79]
    ds_read_b64_tr_b16 v[38:39], v17 offset:33280
    s_add_u32 s1, s8, 7
    s_and_b32 s1, s1, 7
    s_mul_i32 s1, s1, 229376
    s_add_u32 m0, s58, 57344
    s_add_u32 s1, s1, s6
    s_add_u32 s1, s1, 128
    buffer_load_dwordx4 v8, s[24:27], s1 offen lds
    v_mfma_f32_16x16x32_bf16 v[80:83], v[56:59], v[184:187], v[80:83]
    ds_read_b64_tr_b16 v[40:41], v18 offset:32768
    v_mfma_f32_16x16x32_bf16 v[84:87], v[56:59], v[188:191], v[84:87]
    ds_read_b64_tr_b16 v[42:43], v18 offset:33280
    v_mfma_f32_16x16x32_bf16 v[88:91], v[60:63], v[184:187], v[88:91]
    ds_read_b64_tr_b16 v[44:45], v20 offset:32768
    v_mfma_f32_16x16x32_bf16 v[92:95], v[60:63], v[188:191], v[92:95]
    ds_read_b64_tr_b16 v[46:47], v20 offset:33280
    s_add_u32 m0, s58, 58368
    s_nop 0
    buffer_load_dwordx4 v9, s[24:27], s1 offen lds
    s_waitcnt lgkmcnt(0)
    v_mfma_f32_16x16x32_bf16 v[64:67], v[32:35], v[192:195], v[64:67]
    ds_read_b64_tr_b16 v[48:49], v16 offset:36864
    v_mfma_f32_16x16x32_bf16 v[68:71], v[32:35], v[196:199], v[68:71]
    ds_read_b64_tr_b16 v[50:51], v16 offset:37376
    v_mfma_f32_16x16x32_bf16 v[72:75], v[36:39], v[192:195], v[72:75]
    ds_read_b64_tr_b16 v[52:53], v17 offset:36864
    v_mfma_f32_16x16x32_bf16 v[76:79], v[36:39], v[196:199], v[76:79]
    ds_read_b64_tr_b16 v[54:55], v17 offset:37376
    v_mfma_f32_16x16x32_bf16 v[80:83], v[40:43], v[192:195], v[80:83]
    ds_read_b64_tr_b16 v[56:57], v18 offset:36864
    v_mfma_f32_16x16x32_bf16 v[84:87], v[40:43], v[196:199], v[84:87]
    ds_read_b64_tr_b16 v[58:59], v18 offset:37376
    v_mfma_f32_16x16x32_bf16 v[88:91], v[44:47], v[192:195], v[88:91]
    ds_read_b64_tr_b16 v[60:61], v20 offset:36864
    v_mfma_f32_16x16x32_bf16 v[92:95], v[44:47], v[196:199], v[92:95]
    ds_read_b64_tr_b16 v[62:63], v20 offset:37376
    s_waitcnt lgkmcnt(0)
    v_mfma_f32_16x16x32_bf16 v[64:67], v[48:51], v[200:203], v[64:67]
    ds_read_b64_tr_b16 v[32:33], v16 offset:40960
    v_mfma_f32_16x16x32_bf16 v[68:71], v[48:51], v[204:207], v[68:71]
    ds_read_b64_tr_b16 v[34:35], v16 offset:41472
    v_mfma_f32_16x16x32_bf16 v[72:75], v[52:55], v[200:203], v[72:75]
    ds_read_b64_tr_b16 v[36:37], v17 offset:40960
    v_mfma_f32_16x16x32_bf16 v[76:79], v[52:55], v[204:207], v[76:79]
    ds_read_b64_tr_b16 v[38:39], v17 offset:41472
    v_mfma_f32_16x16x32_bf16 v[80:83], v[56:59], v[200:203], v[80:83]
    ds_read_b64_tr_b16 v[40:41], v18 offset:40960
    v_mfma_f32_16x16x32_bf16 v[84:87], v[56:59], v[204:207], v[84:87]
    ds_read_b64_tr_b16 v[42:43], v18 offset:41472
    v_mfma_f32_16x16x32_bf16 v[88:91], v[60:63], v[200:203], v[88:91]
    ds_read_b64_tr_b16 v[44:45], v20 offset:40960
    v_mfma_f32_16x16x32_bf16 v[92:95], v[60:63], v[204:207], v[92:95]
    ds_read_b64_tr_b16 v[46:47], v20 offset:41472
    s_waitcnt lgkmcnt(0)
    v_mfma_f32_16x16x32_bf16 v[64:67], v[32:35], v[208:211], v[64:67]
    ds_read_b64_tr_b16 v[48:49], v16 offset:45056
    v_mfma_f32_16x16x32_bf16 v[68:71], v[32:35], v[212:215], v[68:71]
    ds_read_b64_tr_b16 v[50:51], v16 offset:45568
    v_mfma_f32_16x16x32_bf16 v[72:75], v[36:39], v[208:211], v[72:75]
    ds_read_b64_tr_b16 v[52:53], v17 offset:45056
    v_mfma_f32_16x16x32_bf16 v[76:79], v[36:39], v[212:215], v[76:79]
    ds_read_b64_tr_b16 v[54:55], v17 offset:45568
    v_mfma_f32_16x16x32_bf16 v[80:83], v[40:43], v[208:211], v[80:83]
    ds_read_b64_tr_b16 v[56:57], v18 offset:45056
    v_mfma_f32_16x16x32_bf16 v[84:87], v[40:43], v[212:215], v[84:87]
    ds_read_b64_tr_b16 v[58:59], v18 offset:45568
    v_mfma_f32_16x16x32_bf16 v[88:91], v[44:47], v[208:211], v[88:91]
    ds_read_b64_tr_b16 v[60:61], v20 offset:45056
    v_mfma_f32_16x16x32_bf16 v[92:95], v[44:47], v[212:215], v[92:95]
    ds_read_b64_tr_b16 v[62:63], v20 offset:45568
    s_waitcnt lgkmcnt(0)
    v_mfma_f32_16x16x32_bf16 v[64:67], v[48:51], v[216:219], v[64:67]
    ds_read_b64_tr_b16 v[32:33], v16 offset:49152
    v_mfma_f32_16x16x32_bf16 v[68:71], v[48:51], v[220:223], v[68:71]
    ds_read_b64_tr_b16 v[34:35], v16 offset:49664
    v_mfma_f32_16x16x32_bf16 v[72:75], v[52:55], v[216:219], v[72:75]
    ds_read_b64_tr_b16 v[36:37], v17 offset:49152
    v_mfma_f32_16x16x32_bf16 v[76:79], v[52:55], v[220:223], v[76:79]
    ds_read_b64_tr_b16 v[38:39], v17 offset:49664
    v_mfma_f32_16x16x32_bf16 v[80:83], v[56:59], v[216:219], v[80:83]
    ds_read_b64_tr_b16 v[40:41], v18 offset:49152
    v_mfma_f32_16x16x32_bf16 v[84:87], v[56:59], v[220:223], v[84:87]
    ds_read_b64_tr_b16 v[42:43], v18 offset:49664
    v_mfma_f32_16x16x32_bf16 v[88:91], v[60:63], v[216:219], v[88:91]
    ds_read_b64_tr_b16 v[44:45], v20 offset:49152
    v_mfma_f32_16x16x32_bf16 v[92:95], v[60:63], v[220:223], v[92:95]
    ds_read_b64_tr_b16 v[46:47], v20 offset:49664
    s_waitcnt vmcnt(8)
    v_mov_b32 v19, 1
    s_mov_b64 exec, 1
    ds_add_u32 v25, v19 offset:8
    s_mov_b64 exec, -1
    s_waitcnt lgkmcnt(1)
    v_mfma_f32_16x16x32_bf16 v[64:67], v[32:35], v[224:227], v[64:67]
    ds_read_b64_tr_b16 v[48:49], v16 offset:53248
    v_mfma_f32_16x16x32_bf16 v[68:71], v[32:35], v[228:231], v[68:71]
    ds_read_b64_tr_b16 v[50:51], v16 offset:53760
    v_mfma_f32_16x16x32_bf16 v[72:75], v[36:39], v[224:227], v[72:75]
    ds_read_b64_tr_b16 v[52:53], v17 offset:53248
    v_mfma_f32_16x16x32_bf16 v[76:79], v[36:39], v[228:231], v[76:79]
    ds_read_b64_tr_b16 v[54:55], v17 offset:53760
    v_mfma_f32_16x16x32_bf16 v[80:83], v[40:43], v[224:227], v[80:83]
    ds_read_b64_tr_b16 v[56:57], v18 offset:53248
    v_mfma_f32_16x16x32_bf16 v[84:87], v[40:43], v[228:231], v[84:87]
    ds_read_b64_tr_b16 v[58:59], v18 offset:53760
    v_mfma_f32_16x16x32_bf16 v[88:91], v[44:47], v[224:227], v[88:91]
    ds_read_b64_tr_b16 v[60:61], v20 offset:53248
    v_mfma_f32_16x16x32_bf16 v[92:95], v[44:47], v[228:231], v[92:95]
    ds_read_b64_tr_b16 v[62:63], v20 offset:53760
    s_waitcnt lgkmcnt(0)
    v_mfma_f32_16x16x32_bf16 v[64:67], v[48:51], v[232:235], v[64:67]
    ds_read_b64_tr_b16 v[32:33], v16 offset:57344
    v_mfma_f32_16x16x32_bf16 v[68:71], v[48:51], v[236:239], v[68:71]
    ds_read_b64_tr_b16 v[34:35], v16 offset:57856
    v_mfma_f32_16x16x32_bf16 v[72:75], v[52:55], v[232:235], v[72:75]
    ds_read_b64_tr_b16 v[36:37], v17 offset:57344
    v_mfma_f32_16x16x32_bf16 v[76:79], v[52:55], v[236:239], v[76:79]
    ds_read_b64_tr_b16 v[38:39], v17 offset:57856
    v_mfma_f32_16x16x32_bf16 v[80:83], v[56:59], v[232:235], v[80:83]
    ds_read_b64_tr_b16 v[40:41], v18 offset:57344
    v_mfma_f32_16x16x32_bf16 v[84:87], v[56:59], v[236:239], v[84:87]
    ds_read_b64_tr_b16 v[42:43], v18 offset:57856
    v_mfma_f32_16x16x32_bf16 v[88:91], v[60:63], v[232:235], v[88:91]
    ds_read_b64_tr_b16 v[44:45], v20 offset:57344
    v_mfma_f32_16x16x32_bf16 v[92:95], v[60:63], v[236:239], v[92:95]
    ds_read_b64_tr_b16 v[46:47], v20 offset:57856
    s_waitcnt vmcnt(0)
    v_mov_b32 v19, 1
    s_mov_b64 exec, 1
    ds_add_u32 v25, v19 offset:12
    s_mov_b64 exec, -1
    s_waitcnt lgkmcnt(1)
    ds_read_b32 v107, v25 offset:44
    v_mfma_f32_16x16x32_bf16 v[64:67], v[32:35], v[240:243], v[64:67]
    ds_read_b64_tr_b16 v[48:49], v16 offset:61440
    v_mfma_f32_16x16x32_bf16 v[68:71], v[32:35], v[244:247], v[68:71]
    ds_read_b64_tr_b16 v[50:51], v16 offset:61952
    v_mfma_f32_16x16x32_bf16 v[72:75], v[36:39], v[240:243], v[72:75]
    ds_read_b64_tr_b16 v[52:53], v17 offset:61440
    v_mfma_f32_16x16x32_bf16 v[76:79], v[36:39], v[244:247], v[76:79]
    ds_read_b64_tr_b16 v[54:55], v17 offset:61952
    v_mfma_f32_16x16x32_bf16 v[80:83], v[40:43], v[240:243], v[80:83]
    ds_read_b64_tr_b16 v[56:57], v18 offset:61440
    v_mfma_f32_16x16x32_bf16 v[84:87], v[40:43], v[244:247], v[84:87]
    ds_read_b64_tr_b16 v[58:59], v18 offset:61952
    v_mfma_f32_16x16x32_bf16 v[88:91], v[44:47], v[240:243], v[88:91]
    ds_read_b64_tr_b16 v[60:61], v20 offset:61440
    v_mfma_f32_16x16x32_bf16 v[92:95], v[44:47], v[244:247], v[92:95]
    ds_read_b64_tr_b16 v[62:63], v20 offset:61952
    s_waitcnt lgkmcnt(8)
    v_readfirstlane_b32 s43, v107
    s_cmp_lt_u32 s43, 4
    s_cbranch_scc1 L_gs1
L_gx1:
    ds_read2_b32 v[120:121], v96 offset0:32 offset1:0
    ds_read2_b32 v[122:123], v96 offset0:48 offset1:16
    ds_read_b128 v[108:111], v99 offset:0
    ds_read_b128 v[112:115], v99 offset:64
    ds_read_b128 v[116:119], v99 offset:128
    ds_read_b128 v[124:127], v99 offset:192
    s_waitcnt lgkmcnt(6)
    ds_read_b32 v97, v25 offset:8
    v_mfma_f32_16x16x32_bf16 v[64:67], v[48:51], v[248:251], v[64:67]
    v_mfma_f32_16x16x32_bf16 v[68:71], v[48:51], v[252:255], v[68:71]
    v_mfma_f32_16x16x32_bf16 v[72:75], v[52:55], v[248:251], v[72:75]
    v_mfma_f32_16x16x32_bf16 v[76:79], v[52:55], v[252:255], v[76:79]
    v_mfma_f32_16x16x32_bf16 v[80:83], v[56:59], v[248:251], v[80:83]
    v_mfma_f32_16x16x32_bf16 v[84:87], v[56:59], v[252:255], v[84:87]
    v_mfma_f32_16x16x32_bf16 v[88:91], v[60:63], v[248:251], v[88:91]
    v_mfma_f32_16x16x32_bf16 v[92:95], v[60:63], v[252:255], v[92:95]
    v_mov_b32 v19, 1
    s_mov_b64 exec, 1
    ds_add_u32 v25, v19 offset:4
    s_mov_b64 exec, -1
    s_add_u32 s45, s59, 0
    s_add_u32 s46, s59, 57344
    s_waitcnt lgkmcnt(2)
    v_pk_fma_f32 v[64:65], v[108:109], v[120:121], v[64:65] op_sel_hi:[1,0,1]
    v_pk_fma_f32 v[66:67], v[110:111], v[120:121], v[66:67] op_sel_hi:[1,0,1]
    v_pk_fma_f32 v[72:73], v[112:113], v[120:121], v[72:73] op_sel_hi:[1,0,1]
    v_pk_fma_f32 v[74:75], v[114:115], v[120:121], v[74:75] op_sel_hi:[1,0,1]
    v_cvt_pk_bf16_f32 v32, v64, v65
    v_cvt_pk_bf16_f32 v33, v66, v67
    v_cvt_pk_bf16_f32 v34, v72, v73
    v_cvt_pk_bf16_f32 v35, v74, v75
    v_pk_max_i16 v32, v32, 0
    v_pk_max_i16 v33, v33, 0
    v_pk_max_i16 v34, v34, 0
    v_pk_max_i16 v35, v35, 0
    buffer_store_dwordx4 v[32:35], v2, s[36:39], s45 offen offset:0 sc1
    v_pk_fma_f32 v[68:69], v[108:109], v[122:123], v[68:69] op_sel_hi:[1,0,1]
    v_pk_fma_f32 v[70:71], v[110:111], v[122:123], v[70:71] op_sel_hi:[1,0,1]
    v_pk_fma_f32 v[76:77], v[112:113], v[122:123], v[76:77] op_sel_hi:[1,0,1]
    v_pk_fma_f32 v[78:79], v[114:115], v[122:123], v[78:79] op_sel_hi:[1,0,1]
    v_cvt_pk_bf16_f32 v36, v68, v69
    v_cvt_pk_bf16_f32 v37, v70, v71
    v_cvt_pk_bf16_f32 v38, v76, v77
    v_cvt_pk_bf16_f32 v39, v78, v79
    v_pk_max_i16 v36, v36, 0
    v_pk_max_i16 v37, v37, 0
    v_pk_max_i16 v38, v38, 0
    v_pk_max_i16 v39, v39, 0
    buffer_store_dwordx4 v[36:39], v2, s[36:39], s46 offen offset:0 sc1
    v_pk_fma_f32 v[80:81], v[116:117], v[120:121], v[80:81] op_sel_hi:[1,0,1]
    v_pk_fma_f32 v[82:83], v[118:119], v[120:121], v[82:83] op_sel_hi:[1,0,1]
    v_pk_fma_f32 v[88:89], v[124:125], v[120:121], v[88:89] op_sel_hi:[1,0,1]
    v_pk_fma_f32 v[90:91], v[126:127], v[120:121], v[90:91] op_sel_hi:[1,0,1]
    v_cvt_pk_bf16_f32 v40, v80, v81
    v_cvt_pk_bf16_f32 v41, v82, v83
    v_cvt_pk_bf16_f32 v42, v88, v89
    v_cvt_pk_bf16_f32 v43, v90, v91
    v_pk_max_i16 v40, v40, 0
    v_pk_max_i16 v41, v41, 0
    v_pk_max_i16 v42, v42, 0
    v_pk_max_i16 v43, v43, 0
    buffer_store_dwordx4 v[40:43], v2, s[36:39], s45 offen offset:1024 sc1
    v_pk_fma_f32 v[84:85], v[116:117], v[122:123], v[84:85] op_sel_hi:[1,0,1]
    v_pk_fma_f32 v[86:87], v[118:119], v[122:123], v[86:87] op_sel_hi:[1,0,1]
    v_pk_fma_f32 v[92:93], v[124:125], v[122:123], v[92:93] op_sel_hi:[1,0,1]
    v_pk_fma_f32 v[94:95], v[126:127], v[122:123], v[94:95] op_sel_hi:[1,0,1]
    v_cvt_pk_bf16_f32 v44, v84, v85
    v_cvt_pk_bf16_f32 v45, v86, v87
    v_cvt_pk_bf16_f32 v46, v92, v93
    v_cvt_pk_bf16_f32 v47, v94, v95
    v_pk_max_i16 v44, v44, 0
    v_pk_max_i16 v45, v45, 0
    v_pk_max_i16 v46, v46, 0
    v_pk_max_i16 v47, v47, 0
    buffer_store_dwordx4 v[44:47], v2, s[36:39], s46 offen offset:1024 sc1
    v_subrev_u32 v16, 0x10000, v16
    v_subrev_u32 v17, 0x10000, v17
    v_subrev_u32 v18, 0x10000, v18
    v_subrev_u32 v20, 0x10000, v20
    s_waitcnt lgkmcnt(1)
    v_readfirstlane_b32 s43, v97
    s_cmp_lt_u32 s43, 4
    s_cbranch_scc1 L_gs2
L_gx2:
    ds_read_b64_tr_b16 v[32:33], v16 offset:0
    ds_read_b64_tr_b16 v[34:35], v16 offset:512
    ds_read_b64_tr_b16 v[36:37], v17 offset:0
    ds_read_b64_tr_b16 v[38:39], v17 offset:512
    ds_read_b64_tr_b16 v[40:41], v18 offset:0
    ds_read_b64_tr_b16 v[42:43], v18 offset:512
    ds_read_b64_tr_b16 v[44:45], v20 offset:0
    ds_read_b64_tr_b16 v[46:47], v20 offset:512
    s_waitcnt lgkmcnt(0)
    ds_read_b32 v98, v25 offset:4
    v_mfma_f32_16x16x32_bf16 v[64:67], v[32:35], v[128:131], 0
    ds_read_b64_tr_b16 v[48:49], v16 offset:4096
    v_mfma_f32_16x16x32_bf16 v[68:71], v[32:35], v[132:135], 0
    ds_read_b64_tr_b16 v[50:51], v16 offset:4608
    v_mfma_f32_16x16x32_bf16 v[72:75], v[36:39], v[128:131], 0
    ds_read_b64_tr_b16 v[52:53], v17 offset:4096
    v_mfma_f32_16x16x32_bf16 v[76:79], v[36:39], v[132:135], 0
    ds_read_b64_tr_b16 v[54:55], v17 offset:4608
    v_mfma_f32_16x16x32_bf16 v[80:83], v[40:43], v[128:131], 0
    ds_read_b64_tr_b16 v[56:57], v18 offset:4096
    v_mfma_f32_16x16x32_bf16 v[84:87], v[40:43], v[132:135], 0
    ds_read_b64_tr_b16 v[58:59], v18 offset:4608
    v_mfma_f32_16x16x32_bf16 v[88:91], v[44:47], v[128:131], 0
    ds_read_b64_tr_b16 v[60:61], v20 offset:4096
    v_mfma_f32_16x16x32_bf16 v[92:95], v[44:47], v[132:135], 0
    ds_read_b64_tr_b16 v[62:63], v20 offset:4608
    s_waitcnt lgkmcnt(8)
    v_readfirstlane_b32 s43, v98
    s_cmp_lt_u32 s43, 4
    s_cbranch_scc1 L_gs3
L_gx3:
    s_waitcnt lgkmcnt(0)
    v_mfma_f32_16x16x32_bf16 v[64:67], v[48:51], v[136:139], v[64:67]
    ds_read_b64_tr_b16 v[32:33], v16 offset:8192
    v_mfma_f32_16x16x32_bf16 v[68:71], v[48:51], v[140:143], v[68:71]
    ds_read_b64_tr_b16 v[34:35], v16 offset:8704
    v_mfma_f32_16x16x32_bf16 v[72:75], v[52:55], v[136:139], v[72:75]
    ds_read_b64_tr_b16 v[36:37], v17 offset:8192
    v_mfma_f32_16x16x32_bf16 v[76:79], v[52:55], v[140:143], v[76:79]
    ds_read_b64_tr_b16 v[38:39], v17 offset:8704
    s_add_u32 m0, s58, 65536
    s_lshl_b32 s1, s50, 17
    s_add_u32 s1, s1, s63
    buffer_load_dwordx4 v24, s[28:31], s1 offen lds
    v_mfma_f32_16x16x32_bf16 v[80:83], v[56:59], v[136:139], v[80:83]
    ds_read_b64_tr_b16 v[40:41], v18 offset:8192
    v_mfma_f32_16x16x32_bf16 v[84:87], v[56:59], v[140:143], v[84:87]
    ds_read_b64_tr_b16 v[42:43], v18 offset:8704
    v_mfma_f32_16x16x32_bf16 v[88:91], v[60:63], v[136:139], v[88:91]
    ds_read_b64_tr_b16 v[44:45], v20 offset:8192
    v_mfma_f32_16x16x32_bf16 v[92:95], v[60:63], v[140:143], v[92:95]
    ds_read_b64_tr_b16 v[46:47], v20 offset:8704
    s_add_u32 m0, s58, 66560
    s_add_u32 s1, s1, 8192
    buffer_load_dwordx4 v24, s[28:31], s1 offen lds
    s_waitcnt lgkmcnt(0)
    v_mfma_f32_16x16x32_bf16 v[64:67], v[32:35], v[144:147], v[64:67]
    ds_read_b64_tr_b16 v[48:49], v16 offset:12288
    v_mfma_f32_16x16x32_bf16 v[68:71], v[32:35], v[148:151], v[68:71]
    ds_read_b64_tr_b16 v[50:51], v16 offset:12800
    v_mfma_f32_16x16x32_bf16 v[72:75], v[36:39], v[144:147], v[72:75]
    ds_read_b64_tr_b16 v[52:53], v17 offset:12288
    v_mfma_f32_16x16x32_bf16 v[76:79], v[36:39], v[148:151], v[76:79]
    ds_read_b64_tr_b16 v[54:55], v17 offset:12800
    s_add_u32 m0, s58, 73728
    s_lshl_b32 s1, s51, 17
    s_add_u32 s1, s1, s63
    buffer_load_dwordx4 v24, s[28:31], s1 offen lds
    v_mfma_f32_16x16x32_bf16 v[80:83], v[40:43], v[144:147], v[80:83]
    ds_read_b64_tr_b16 v[56:57], v18 offset:12288
    v_mfma_f32_16x16x32_bf16 v[84:87], v[40:43], v[148:151], v[84:87]
    ds_read_b64_tr_b16 v[58:59], v18 offset:12800
    v_mfma_f32_16x16x32_bf16 v[88:91], v[44:47], v[144:147], v[88:91]
    ds_read_b64_tr_b16 v[60:61], v20 offset:12288
    v_mfma_f32_16x16x32_bf16 v[92:95], v[44:47], v[148:151], v[92:95]
    ds_read_b64_tr_b16 v[62:63], v20 offset:12800
    s_add_u32 m0, s58, 74752
    s_add_u32 s1, s1, 8192
    buffer_load_dwordx4 v24, s[28:31], s1 offen lds
    s_waitcnt lgkmcnt(0)
    v_mfma_f32_16x16x32_bf16 v[64:67], v[48:51], v[152:155], v[64:67]
    ds_read_b64_tr_b16 v[32:33], v16 offset:16384
    v_mfma_f32_16x16x32_bf16 v[68:71], v[48:51], v[156:159], v[68:71]
    ds_read_b64_tr_b16 v[34:35], v16 offset:16896
    v_mfma_f32_16x16x32_bf16 v[72:75], v[52:55], v[152:155], v[72:75]
    ds_read_b64_tr_b16 v[36:37], v17 offset:16384
    v_mfma_f32_16x16x32_bf16 v[76:79], v[52:55], v[156:159], v[76:79]
    ds_read_b64_tr_b16 v[38:39], v17 offset:16896
    s_add_u32 m0, s58, 81920
    s_lshl_b32 s1, s52, 17
    s_add_u32 s1, s1, s63
    buffer_load_dwordx4 v24, s[28:31], s1 offen lds
    v_mfma_f32_16x16x32_bf16 v[80:83], v[56:59], v[152:155], v[80:83]
    ds_read_b64_tr_b16 v[40:41], v18 offset:16384
    v_mfma_f32_16x16x32_bf16 v[84:87], v[56:59], v[156:159], v[84:87]
    ds_read_b64_tr_b16 v[42:43], v18 offset:16896
    v_mfma_f32_16x16x32_bf16 v[88:91], v[60:63], v[152:155], v[88:91]
    ds_read_b64_tr_b16 v[44:45], v20 offset:16384
    v_mfma_f32_16x16x32_bf16 v[92:95], v[60:63], v[156:159], v[92:95]
    ds_read_b64_tr_b16 v[46:47], v20 offset:16896
    s_add_u32 m0, s58, 82944
    s_add_u32 s1, s1, 8192
    buffer_load_dwordx4 v24, s[28:31], s1 offen lds
    s_waitcnt vmcnt(6)
    s_mov_b64 exec, 1
    buffer_store_dword v5, off, s[36:39], s60 sc1
    s_mov_b64 exec, -1
    s_add_u32 s60, s60, 0x8000
    s_waitcnt lgkmcnt(0)
    v_mfma_f32_16x16x32_bf16 v[64:67], v[32:35], v[160:163], v[64:67]
    ds_read_b64_tr_b16 v[48:49], v16 offset:20480
    v_mfma_f32_16x16x32_bf16 v[68:71], v[32:35], v[164:167], v[68:71]
    ds_read_b64_tr_b16 v[50:51], v16 offset:20992
    v_mfma_f32_16x16x32_bf16 v[72:75], v[36:39], v[160:163], v[72:75]
    ds_read_b64_tr_b16 v[52:53], v17 offset:20480
    v_mfma_f32_16x16x32_bf16 v[76:79], v[36:39], v[164:167], v[76:79]
    ds_read_b64_tr_b16 v[54:55], v17 offset:20992
    s_add_u32 m0, s58, 90112
    s_lshl_b32 s1, s53, 17
    s_add_u32 s1, s1, s63
    buffer_load_dwordx4 v24, s[28:31], s1 offen lds
    v_mfma_f32_16x16x32_bf16 v[80:83], v[40:43], v[160:163], v[80:83]
    ds_read_b64_tr_b16 v[56:57], v18 offset:20480
    v_mfma_f32_16x16x32_bf16 v[84:87], v[40:43], v[164:167], v[84:87]
    ds_read_b64_tr_b16 v[58:59], v18 offset:20992
    v_mfma_f32_16x16x32_bf16 v[88:91], v[44:47], v[160:163], v[88:91]
    ds_read_b64_tr_b16 v[60:61], v20 offset:20480
    v_mfma_f32_16x16x32_bf16 v[92:95], v[44:47], v[164:167], v[92:95]
    ds_read_b64_tr_b16 v[62:63], v20 offset:20992
    s_add_u32 m0, s58, 91136
    s_add_u32 s1, s1, 8192
    buffer_load_dwordx4 v24, s[28:31], s1 offen lds
    s_waitcnt lgkmcnt(0)
    v_mfma_f32_16x16x32_bf16 v[64:67], v[48:51], v[168:171], v[64:67]
    ds_read_b64_tr_b16 v[32:33], v16 offset:24576
    v_mfma_f32_16x16x32_bf16 v[68:71], v[48:51], v[172:175], v[68:71]
    ds_read_b64_tr_b16 v[34:35], v16 offset:25088
    v_mfma_f32_16x16x32_bf16 v[72:75], v[52:55], v[168:171], v[72:75]
    ds_read_b64_tr_b16 v[36:37], v17 offset:24576
    v_mfma_f32_16x16x32_bf16 v[76:79], v[52:55], v[172:175], v[76:79]
    ds_read_b64_tr_b16 v[38:39], v17 offset:25088
    s_add_u32 m0, s58, 98304
    s_lshl_b32 s1, s54, 17
    s_add_u32 s1, s1, s63
    buffer_load_dwordx4 v24, s[28:31], s1 offen lds
    v_mfma_f32_16x16x32_bf16 v[80:83], v[56:59], v[168:171], v[80:83]
    ds_read_b64_tr_b16 v[40:41], v18 offset:24576
    v_mfma_f32_16x16x32_bf16 v[84:87], v[56:59], v[172:175], v[84:87]
    ds_read_b64_tr_b16 v[42:43], v18 offset:25088
    v_mfma_f32_16x16x32_bf16 v[88:91], v[60:63], v[168:171], v[88:91]
    ds_read_b64_tr_b16 v[44:45], v20 offset:24576
    v_mfma_f32_16x16x32_bf16 v[92:95], v[60:63], v[172:175], v[92:95]
    ds_read_b64_tr_b16 v[46:47], v20 offset:25088
    s_add_u32 m0, s58, 99328
    s_add_u32 s1, s1, 8192
    buffer_load_dwordx4 v24, s[28:31], s1 offen lds
    s_waitcnt lgkmcnt(0)
    ds_read_b32 v107, v25 offset:12
    v_mfma_f32_16x16x32_bf16 v[64:67], v[32:35], v[176:179], v[64:67]
    ds_read_b64_tr_b16 v[48:49], v16 offset:28672
    v_mfma_f32_16x16x32_bf16 v[68:71], v[32:35], v[180:183], v[68:71]
    ds_read_b64_tr_b16 v[50:51], v16 offset:29184
    v_mfma_f32_16x16x32_bf16 v[72:75], v[36:39], v[176:179], v[72:75]
    ds_read_b64_tr_b16 v[52:53], v17 offset:28672
    v_mfma_f32_16x16x32_bf16 v[76:79], v[36:39], v[180:183], v[76:79]
    ds_read_b64_tr_b16 v[54:55], v17 offset:29184
    s_add_u32 m0, s58, 106496
    s_lshl_b32 s1, s55, 17
    s_add_u32 s1, s1, s63
    buffer_load_dwordx4 v24, s[28:31], s1 offen lds
    v_mfma_f32_16x16x32_bf16 v[80:83], v[40:43], v[176:179], v[80:83]
    ds_read_b64_tr_b16 v[56:57], v18 offset:28672
    v_mfma_f32_16x16x32_bf16 v[84:87], v[40:43], v[180:183], v[84:87]
    ds_read_b64_tr_b16 v[58:59], v18 offset:29184
    v_mfma_f32_16x16x32_bf16 v[88:91], v[44:47], v[176:179], v[88:91]
    ds_read_b64_tr_b16 v[60:61], v20 offset:28672
    v_mfma_f32_16x16x32_bf16 v[92:95], v[44:47], v[180:183], v[92:95]
    ds_read_b64_tr_b16 v[62:63], v20 offset:29184
    s_add_u32 m0, s58, 107520
    s_add_u32 s1, s1, 8192
    buffer_load_dwordx4 v24, s[28:31], s1 offen lds
    s_waitcnt lgkmcnt(0)
    v_readfirstlane_b32 s43, v107
    s_cmp_lt_u32 s43, 4
    s_cbranch_scc1 L_gs4
L_gx4:
    v_mfma_f32_16x16x32_bf16 v[64:67], v[48:51], v[184:187], v[64:67]
    ds_read_b64_tr_b16 v[32:33], v16 offset:32768
    v_mfma_f32_16x16x32_bf16 v[68:71], v[48:51], v[188:191], v[68:71]
    ds_read_b64_tr_b16 v[34:35], v16 offset:33280
    v_mfma_f32_16x16x32_bf16 v[72:75], v[52:55], v[184:187], v[72:75]
    ds_read_b64_tr_b16 v[36:37], v17 offset:32768
    v_mfma_f32_16x16x32_bf16 v[76:79], v[52:55], v[188:191], v[76:79]
    ds_read_b64_tr_b16 v[38:39], v17 offset:33280
    s_add_u32 m0, s58, 114688
    s_lshl_b32 s1, s56, 17
    s_add_u32 s1, s1, s63
    buffer_load_dwordx4 v24, s[28:31], s1 offen lds
    v_mfma_f32_16x16x32_bf16 v[80:83], v[56:59], v[184:187], v[80:83]
    ds_read_b64_tr_b16 v[40:41], v18 offset:32768
    v_mfma_f32_16x16x32_bf16 v[84:87], v[56:59], v[188:191], v[84:87]
    ds_read_b64_tr_b16 v[42:43], v18 offset:33280
    v_mfma_f32_16x16x32_bf16 v[88:91], v[60:63], v[184:187], v[88:91]
    ds_read_b64_tr_b16 v[44:45], v20 offset:32768
    v_mfma_f32_16x16x32_bf16 v[92:95], v[60:63], v[188:191], v[92:95]
    ds_read_b64_tr_b16 v[46:47], v20 offset:33280
    s_add_u32 m0, s58, 115712
    s_add_u32 s1, s1, 8192
    buffer_load_dwordx4 v24, s[28:31], s1 offen lds
    s_waitcnt lgkmcnt(0)
    v_mfma_f32_16x16x32_bf16 v[64:67], v[32:35], v[192:195], v[64:67]
    ds_read_b64_tr_b16 v[48:49], v16 offset:36864
    v_mfma_f32_16x16x32_bf16 v[68:71], v[32:35], v[196:199], v[68:71]
    ds_read_b64_tr_b16 v[50:51], v16 offset:37376
    v_mfma_f32_16x16x32_bf16 v[72:75], v[36:39], v[192:195], v[72:75]
    ds_read_b64_tr_b16 v[52:53], v17 offset:36864
    v_mfma_f32_16x16x32_bf16 v[76:79], v[36:39], v[196:199], v[76:79]
    ds_read_b64_tr_b16 v[54:55], v17 offset:37376
    v_mfma_f32_16x16x32_bf16 v[80:83], v[40:43], v[192:195], v[80:83]
    ds_read_b64_tr_b16 v[56:57], v18 offset:36864
    v_mfma_f32_16x16x32_bf16 v[84:87], v[40:43], v[196:199], v[84:87]
    ds_read_b64_tr_b16 v[58:59], v18 offset:37376
    v_mfma_f32_16x16x32_bf16 v[88:91], v[44:47], v[192:195], v[88:91]
    ds_read_b64_tr_b16 v[60:61], v20 offset:36864
    v_mfma_f32_16x16x32_bf16 v[92:95], v[44:47], v[196:199], v[92:95]
    ds_read_b64_tr_b16 v[62:63], v20 offset:37376
    v_mov_b32 v19, 1
    s_mov_b64 exec, 1
    ds_add_u32 v25, v19 offset:52
    s_mov_b64 exec, -1
    s_waitcnt lgkmcnt(1)
    v_mfma_f32_16x16x32_bf16 v[64:67], v[48:51], v[200:203], v[64:67]
    ds_read_b64_tr_b16 v[32:33], v16 offset:40960
    v_mfma_f32_16x16x32_bf16 v[68:71], v[48:51], v[204:207], v[68:71]
    ds_read_b64_tr_b16 v[34:35], v16 offset:41472
    v_mfma_f32_16x16x32_bf16 v[72:75], v[52:55], v[200:203], v[72:75]
    ds_read_b64_tr_b16 v[36:37], v17 offset:40960
    v_mfma_f32_16x16x32_bf16 v[76:79], v[52:55], v[204:207], v[76:79]
    ds_read_b64_tr_b16 v[38:39], v17 offset:41472
    v_mfma_f32_16x16x32_bf16 v[80:83], v[56:59], v[200:203], v[80:83]
    ds_read_b64_tr_b16 v[40:41], v18 offset:40960
    v_mfma_f32_16x16x32_bf16 v[84:87], v[56:59], v[204:207], v[84:87]
    ds_read_b64_tr_b16 v[42:43], v18 offset:41472
    v_mfma_f32_16x16x32_bf16 v[88:91], v[60:63], v[200:203], v[88:91]
    ds_read_b64_tr_b16 v[44:45], v20 offset:40960
    v_mfma_f32_16x16x32_bf16 v[92:95], v[60:63], v[204:207], v[92:95]
    ds_read_b64_tr_b16 v[46:47], v20 offset:41472
    s_waitcnt lgkmcnt(0)
    ds_read_b32 v107, v25 offset:48
    ds_read_b32 v97, v25 offset:52
    v_mfma_f32_16x16x32_bf16 v[64:67], v[32:35], v[208:211], v[64:67]
    ds_read_b64_tr_b16 v[48:49], v16 offset:45056
    v_mfma_f32_16x16x32_bf16 v[68:71], v[32:35], v[212:215], v[68:71]
    ds_read_b64_tr_b16 v[50:51], v16 offset:45568
    v_mfma_f32_16x16x32_bf16 v[72:75], v[36:39], v[208:211], v[72:75]
    ds_read_b64_tr_b16 v[52:53], v17 offset:45056
    v_mfma_f32_16x16x32_bf16 v[76:79], v[36:39], v[212:215], v[76:79]
    ds_read_b64_tr_b16 v[54:55], v17 offset:45568
    v_mfma_f32_16x16x32_bf16 v[80:83], v[40:43], v[208:211], v[80:83]
    ds_read_b64_tr_b16 v[56:57], v18 offset:45056
    v_mfma_f32_16x16x32_bf16 v[84:87], v[40:43], v[212:215], v[84:87]
    ds_read_b64_tr_b16 v[58:59], v18 offset:45568
    v_mfma_f32_16x16x32_bf16 v[88:91], v[44:47], v[208:211], v[88:91]
    ds_read_b64_tr_b16 v[60:61], v20 offset:45056
    v_mfma_f32_16x16x32_bf16 v[92:95], v[44:47], v[212:215], v[92:95]
    ds_read_b64_tr_b16 v[62:63], v20 offset:45568
    s_waitcnt lgkmcnt(9)
    v_readfirstlane_b32 s43, v107
    s_cmp_lt_u32 s43, 4
    s_cbranch_scc1 L_gs5
L_gx5:
    ds_read_b128 v[108:111], v99 offset:256
    ds_read_b128 v[112:115], v99 offset:320
    ds_read_b128 v[116:119], v99 offset:384
    ds_read_b128 v[124:127], v99 offset:448
    s_waitcnt lgkmcnt(12)
    v_readfirstlane_b32 s43, v97
    s_cmp_lt_u32 s43, 4
    s_cbranch_scc1 L_gs6
L_gx6:
    s_waitcnt lgkmcnt(4)
    v_mfma_f32_16x16x32_bf16 v[64:67], v[48:51], v[216:219], v[64:67]
    ds_read_b64_tr_b16 v[32:33], v16 offset:49152
    v_mfma_f32_16x16x32_bf16 v[68:71], v[48:51], v[220:223], v[68:71]
    ds_read_b64_tr_b16 v[34:35], v16 offset:49664
    v_mfma_f32_16x16x32_bf16 v[72:75], v[52:55], v[216:219], v[72:75]
    ds_read_b64_tr_b16 v[36:37], v17 offset:49152
    v_mfma_f32_16x16x32_bf16 v[76:79], v[52:55], v[220:223], v[76:79]
    ds_read_b64_tr_b16 v[38:39], v17 offset:49664
    s_add_u32 m0, s58, 0
    s_lshl_b32 s1, s50, 17
    s_add_u32 s1, s1, s63
    s_add_u32 s1, s1, 0x10000
    buffer_load_dwordx4 v24, s[28:31], s1 offen lds
    v_mfma_f32_16x16x32_bf16 v[80:83], v[56:59], v[216:219], v[80:83]
    ds_read_b64_tr_b16 v[40:41], v18 offset:49152
    v_mfma_f32_16x16x32_bf16 v[84:87], v[56:59], v[220:223], v[84:87]
    ds_read_b64_tr_b16 v[42:43], v18 offset:49664
    v_mfma_f32_16x16x32_bf16 v[88:91], v[60:63], v[216:219], v[88:91]
    ds_read_b64_tr_b16 v[44:45], v20 offset:49152
    v_mfma_f32_16x16x32_bf16 v[92:95], v[60:63], v[220:223], v[92:95]
    ds_read_b64_tr_b16 v[46:47], v20 offset:49664
    s_add_u32 m0, s58, 1024
    s_add_u32 s1, s1, 8192
    buffer_load_dwordx4 v24, s[28:31], s1 offen lds
    s_waitcnt lgkmcnt(0)
    v_mfma_f32_16x16x32_bf16 v[64:67], v[32:35], v[224:227], v[64:67]
    ds_read_b64_tr_b16 v[48:49], v16 offset:53248
    v_mfma_f32_16x16x32_bf16 v[68:71], v[32:35], v[228:231], v[68:71]
    ds_read_b64_tr_b16 v[50:51], v16 offset:53760
    v_mfma_f32_16x16x32_bf16 v[72:75], v[36:39], v[224:227], v[72:75]
    ds_read_b64_tr_b16 v[52:53], v17 offset:53248
    v_mfma_f32_16x16x32_bf16 v[76:79], v[36:39], v[228:231], v[76:79]
    ds_read_b64_tr_b16 v[54:55], v17 offset:53760
    s_add_u32 m0, s58, 8192
    s_lshl_b32 s1, s51, 17
    s_add_u32 s1, s1, s63
    s_add_u32 s1, s1, 0x10000
    buffer_load_dwordx4 v24, s[28:31], s1 offen lds
    v_mfma_f32_16x16x32_bf16 v[80:83], v[40:43], v[224:227], v[80:83]
    ds_read_b64_tr_b16 v[56:57], v18 offset:53248
    v_mfma_f32_16x16x32_bf16 v[84:87], v[40:43], v[228:231], v[84:87]
    ds_read_b64_tr_b16 v[58:59], v18 offset:53760
    v_mfma_f32_16x16x32_bf16 v[88:91], v[44:47], v[224:227], v[88:91]
    ds_read_b64_tr_b16 v[60:61], v20 offset:53248
    v_mfma_f32_16x16x32_bf16 v[92:95], v[44:47], v[228:231], v[92:95]
    ds_read_b64_tr_b16 v[62:63], v20 offset:53760
    s_add_u32 m0, s58, 9216
    s_add_u32 s1, s1, 8192
    buffer_load_dwordx4 v24, s[28:31], s1 offen lds
    buffer_load_dword v31, v106, s[36:39], s62 offen sc1
    s_waitcnt lgkmcnt(0)
    v_mfma_f32_16x16x32_bf16 v[64:67], v[48:51], v[232:235], v[64:67]
    ds_read_b64_tr_b16 v[32:33], v16 offset:57344
    v_mfma_f32_16x16x32_bf16 v[68:71], v[48:51], v[236:239], v[68:71]
    ds_read_b64_tr_b16 v[34:35], v16 offset:57856
    v_mfma_f32_16x16x32_bf16 v[72:75], v[52:55], v[232:235], v[72:75]
    ds_read_b64_tr_b16 v[36:37], v17 offset:57344
    v_mfma_f32_16x16x32_bf16 v[76:79], v[52:55], v[236:239], v[76:79]
    ds_read_b64_tr_b16 v[38:39], v17 offset:57856
    s_add_u32 m0, s58, 16384
    s_lshl_b32 s1, s52, 17
    s_add_u32 s1, s1, s63
    s_add_u32 s1, s1, 0x10000
    buffer_load_dwordx4 v24, s[28:31], s1 offen lds
    v_mfma_f32_16x16x32_bf16 v[80:83], v[56:59], v[232:235], v[80:83]
    ds_read_b64_tr_b16 v[40:41], v18 offset:57344
    v_mfma_f32_16x16x32_bf16 v[84:87], v[56:59], v[236:239], v[84:87]
    ds_read_b64_tr_b16 v[42:43], v18 offset:57856
    v_mfma_f32_16x16x32_bf16 v[88:91], v[60:63], v[232:235], v[88:91]
    ds_read_b64_tr_b16 v[44:45], v20 offset:57344
    v_mfma_f32_16x16x32_bf16 v[92:95], v[60:63], v[236:239], v[92:95]
    ds_read_b64_tr_b16 v[46:47], v20 offset:57856
    s_add_u32 m0, s58, 17408
    s_add_u32 s1, s1, 8192
    buffer_load_dwordx4 v24, s[28:31], s1 offen lds
    s_waitcnt vmcnt(7)
    v_mov_b32 v19, 1
    s_mov_b64 exec, 1
    ds_add_u32 v25, v19 offset:32
    s_mov_b64 exec, -1
    s_waitcnt lgkmcnt(1)
    v_mfma_f32_16x16x32_bf16 v[64:67], v[32:35], v[240:243], v[64:67]
    ds_read_b64_tr_b16 v[48:49], v16 offset:61440
    v_mfma_f32_16x16x32_bf16 v[68:71], v[32:35], v[244:247], v[68:71]
    ds_read_b64_tr_b16 v[50:51], v16 offset:61952
    v_mfma_f32_16x16x32_bf16 v[72:75], v[36:39], v[240:243], v[72:75]
    ds_read_b64_tr_b16 v[52:53], v17 offset:61440
    v_mfma_f32_16x16x32_bf16 v[76:79], v[36:39], v[244:247], v[76:79]
    ds_read_b64_tr_b16 v[54:55], v17 offset:61952
    s_add_u32 m0, s58, 24576
    s_lshl_b32 s1, s53, 17
    s_add_u32 s1, s1, s63
    s_add_u32 s1, s1, 0x10000
    buffer_load_dwordx4 v24, s[28:31], s1 offen lds
    v_mfma_f32_16x16x32_bf16 v[80:83], v[40:43], v[240:243], v[80:83]
    ds_read_b64_tr_b16 v[56:57], v18 offset:61440
    v_mfma_f32_16x16x32_bf16 v[84:87], v[40:43], v[244:247], v[84:87]
    ds_read_b64_tr_b16 v[58:59], v18 offset:61952
    v_mfma_f32_16x16x32_bf16 v[88:91], v[44:47], v[240:243], v[88:91]
    ds_read_b64_tr_b16 v[60:61], v20 offset:61440
    v_mfma_f32_16x16x32_bf16 v[92:95], v[44:47], v[244:247], v[92:95]
    ds_read_b64_tr_b16 v[62:63], v20 offset:61952
    s_add_u32 m0, s58, 25600
    s_add_u32 s1, s1, 8192
    buffer_load_dwordx4 v24, s[28:31], s1 offen lds
    s_waitcnt lgkmcnt(0)
    v_mfma_f32_16x16x32_bf16 v[64:67], v[48:51], v[248:251], v[64:67]
    v_mfma_f32_16x16x32_bf16 v[68:71], v[48:51], v[252:255], v[68:71]
    v_mfma_f32_16x16x32_bf16 v[72:75], v[52:55], v[248:251], v[72:75]
    v_mfma_f32_16x16x32_bf16 v[76:79], v[52:55], v[252:255], v[76:79]
    v_mfma_f32_16x16x32_bf16 v[80:83], v[56:59], v[248:251], v[80:83]
    v_mfma_f32_16x16x32_bf16 v[84:87], v[56:59], v[252:255], v[84:87]
    v_mfma_f32_16x16x32_bf16 v[88:91], v[60:63], v[248:251], v[88:91]
    v_mfma_f32_16x16x32_bf16 v[92:95], v[60:63], v[252:255], v[92:95]
    ds_read_b32 v97, v25 offset:32
    v_mov_b32 v19, 1
    s_mov_b64 exec, 1
    ds_add_u32 v25, v19 offset:16
    s_mov_b64 exec, -1
    s_add_u32 s45, s59, 2048
    s_add_u32 s46, s59, 59392
    v_pk_fma_f32 v[64:65], v[108:109], v[120:121], v[64:65] op_sel_hi:[1,0,1]
    v_pk_fma_f32 v[66:67], v[110:111], v[120:121], v[66:67] op_sel_hi:[1,0,1]
    v_pk_fma_f32 v[72:73], v[112:113], v[120:121], v[72:73] op_sel_hi:[1,0,1]
    v_pk_fma_f32 v[74:75], v[114:115], v[120:121], v[74:75] op_sel_hi:[1,0,1]
    v_cvt_pk_bf16_f32 v32, v64, v65
    v_cvt_pk_bf16_f32 v33, v66, v67
    v_cvt_pk_bf16_f32 v34, v72, v73
    v_cvt_pk_bf16_f32 v35, v74, v75
    v_pk_max_i16 v32, v32, 0
    v_pk_max_i16 v33, v33, 0
    v_pk_max_i16 v34, v34, 0
    v_pk_max_i16 v35, v35, 0
    buffer_store_dwordx4 v[32:35], v2, s[36:39], s45 offen offset:0 sc1
    v_pk_fma_f32 v[68:69], v[108:109], v[122:123], v[68:69] op_sel_hi:[1,0,1]
    v_pk_fma_f32 v[70:71], v[110:111], v[122:123], v[70:71] op_sel_hi:[1,0,1]
    v_pk_fma_f32 v[76:77], v[112:113], v[122:123], v[76:77] op_sel_hi:[1,0,1]
    v_pk_fma_f32 v[78:79], v[114:115], v[122:123], v[78:79] op_sel_hi:[1,0,1]
    v_cvt_pk_bf16_f32 v36, v68, v69
    v_cvt_pk_bf16_f32 v37, v70, v71
    v_cvt_pk_bf16_f32 v38, v76, v77
    v_cvt_pk_bf16_f32 v39, v78, v79
    v_pk_max_i16 v36, v36, 0
    v_pk_max_i16 v37, v37, 0
    v_pk_max_i16 v38, v38, 0
    v_pk_max_i16 v39, v39, 0
    buffer_store_dwordx4 v[36:39], v2, s[36:39], s46 offen offset:0 sc1
    v_pk_fma_f32 v[80:81], v[116:117], v[120:121], v[80:81] op_sel_hi:[1,0,1]
    v_pk_fma_f32 v[82:83], v[118:119], v[120:121], v[82:83] op_sel_hi:[1,0,1]
    v_pk_fma_f32 v[88:89], v[124:125], v[120:121], v[88:89] op_sel_hi:[1,0,1]
    v_pk_fma_f32 v[90:91], v[126:127], v[120:121], v[90:91] op_sel_hi:[1,0,1]
    v_cvt_pk_bf16_f32 v40, v80, v81
    v_cvt_pk_bf16_f32 v41, v82, v83
    v_cvt_pk_bf16_f32 v42, v88, v89
    v_cvt_pk_bf16_f32 v43, v90, v91
    v_pk_max_i16 v40, v40, 0
    v_pk_max_i16 v41, v41, 0
    v_pk_max_i16 v42, v42, 0
    v_pk_max_i16 v43, v43, 0
    buffer_store_dwordx4 v[40:43], v2, s[36:39], s45 offen offset:1024 sc1
    v_pk_fma_f32 v[84:85], v[116:117], v[122:123], v[84:85] op_sel_hi:[1,0,1]
    v_pk_fma_f32 v[86:87], v[118:119], v[122:123], v[86:87] op_sel_hi:[1,0,1]
    v_pk_fma_f32 v[92:93], v[124:125], v[122:123], v[92:93] op_sel_hi:[1,0,1]
    v_pk_fma_f32 v[94:95], v[126:127], v[122:123], v[94:95] op_sel_hi:[1,0,1]
    v_cvt_pk_bf16_f32 v44, v84, v85
    v_cvt_pk_bf16_f32 v45, v86, v87
    v_cvt_pk_bf16_f32 v46, v92, v93
    v_cvt_pk_bf16_f32 v47, v94, v95
    v_pk_max_i16 v44, v44, 0
    v_pk_max_i16 v45, v45, 0
    v_pk_max_i16 v46, v46, 0
    v_pk_max_i16 v47, v47, 0
    buffer_store_dwordx4 v[44:47], v2, s[36:39], s46 offen offset:1024 sc1
    s_waitcnt vmcnt(8)
    v_cmp_ne_u32 vcc, v31, v5
    s_cmp_lg_u64 vcc, 0
    s_cbranch_scc1 L_slow0
L_back0:
    s_lshl_b32 s0, s50, 12
    s_add_u32 s0, s0, s61
    buffer_load_dwordx4 v[128:131], v104, s[36:39], s0 offen offset:0 sc1
    buffer_load_dwordx4 v[132:135], v105, s[36:39], s0 offen offset:0 sc1
    buffer_load_dwordx4 v[136:139], v104, s[36:39], s0 offen offset:1024 sc1
    buffer_load_dwordx4 v[140:143], v105, s[36:39], s0 offen offset:1024 sc1
    s_lshl_b32 s0, s51, 12
    s_add_u32 s0, s0, s61
    buffer_load_dwordx4 v[144:147], v104, s[36:39], s0 offen offset:0 sc1
    buffer_load_dwordx4 v[148:151], v105, s[36:39], s0 offen offset:0 sc1
    buffer_load_dwordx4 v[152:155], v104, s[36:39], s0 offen offset:1024 sc1
    buffer_load_dwordx4 v[156:159], v105, s[36:39], s0 offen offset:1024 sc1
    s_lshl_b32 s0, s52, 12
    s_add_u32 s0, s0, s61
    buffer_load_dwordx4 v[160:163], v104, s[36:39], s0 offen offset:0 sc1
    buffer_load_dwordx4 v[164:167], v105, s[36:39], s0 offen offset:0 sc1
    buffer_load_dwordx4 v[168:171], v104, s[36:39], s0 offen offset:1024 sc1
    buffer_load_dwordx4 v[172:175], v105, s[36:39], s0 offen offset:1024 sc1
    s_waitcnt lgkmcnt(1)
    v_readfirstlane_b32 s43, v97
    s_cmp_lt_u32 s43, 4
    s_cbranch_scc1 L_gs7
L_gx7:
    ds_read_b64_tr_b16 v[32:33], v100 offset:0
    ds_read_b64_tr_b16 v[34:35], v100 offset:2048
    ds_read_b64_tr_b16 v[36:37], v101 offset:0
    ds_read_b64_tr_b16 v[38:39], v101 offset:2048
    ds_read_b64_tr_b16 v[40:41], v102 offset:0
    ds_read_b64_tr_b16 v[42:43], v102 offset:2048
    ds_read_b64_tr_b16 v[44:45], v103 offset:0
    ds_read_b64_tr_b16 v[46:47], v103 offset:2048
    ds_read_b32 v98, v25 offset:16
    s_waitcnt lgkmcnt(1)
    s_waitcnt lgkmcnt(0)
    v_readfirstlane_b32 s43, v98
    s_cmp_lt_u32 s43, 4
    s_cbranch_scc1 L_gs8
L_gx8:
    s_waitcnt vmcnt(10)
    s_mov_b64 exec, 1
    buffer_store_dword v5, off, s[36:39], s60 sc1
    s_mov_b64 exec, -1
    v_mfma_f32_16x16x32_bf16 v[64:67], v[32:35], v[128:131], 0
    ds_read_b64_tr_b16 v[48:49], v100 offset:4096
    ds_read_b64_tr_b16 v[50:51], v100 offset:6144
    v_mfma_f32_16x16x32_bf16 v[80:83], v[32:35], v[132:135], 0
    ds_read_b64_tr_b16 v[52:53], v101 offset:4096
    ds_read_b64_tr_b16 v[54:55], v101 offset:6144
    s_lshl_b32 s0, s53, 12
    s_add_u32 s0, s0, s61
    buffer_load_dwordx4 v[176:179], v104, s[36:39], s0 offen offset:0 sc1
    v_mfma_f32_16x16x32_bf16 v[68:71], v[36:39], v[128:131], 0
    ds_read_b64_tr_b16 v[56:57], v102 offset:4096
    ds_read_b64_tr_b16 v[58:59], v102 offset:6144
    v_mfma_f32_16x16x32_bf16 v[84:87], v[36:39], v[132:135], 0
    ds_read_b64_tr_b16 v[60:61], v103 offset:4096
    ds_read_b64_tr_b16 v[62:63], v103 offset:6144
    buffer_load_dwordx4 v[180:183], v105, s[36:39], s0 offen offset:0 sc1
    v_mfma_f32_16x16x32_bf16 v[72:75], v[40:43], v[128:131], 0
    v_mfma_f32_16x16x32_bf16 v[88:91], v[40:43], v[132:135], 0
    s_add_u32 m0, s58, 32768
    s_lshl_b32 s1, s54, 17
    s_add_u32 s1, s1, s63
    s_add_u32 s1, s1, 0x10000
    buffer_load_dwordx4 v24, s[28:31], s1 offen lds
    v_mfma_f32_16x16x32_bf16 v[76:79], v[44:47], v[128:131], 0
    v_mfma_f32_16x16x32_bf16 v[92:95], v[44:47], v[132:135], 0
    s_add_u32 m0, s58, 33792
    s_add_u32 s1, s1, 8192
    buffer_load_dwordx4 v24, s[28:31], s1 offen lds
    s_waitcnt lgkmcnt(0)
    s_waitcnt vmcnt(13)
    v_mfma_f32_16x16x32_bf16 v[64:67], v[48:51], v[136:139], v[64:67]
    ds_read_b64_tr_b16 v[32:33], v100 offset:8192
    ds_read_b64_tr_b16 v[34:35], v100 offset:10240
    v_mfma_f32_16x16x32_bf16 v[80:83], v[48:51], v[140:143], v[80:83]
    ds_read_b64_tr_b16 v[36:37], v101 offset:8192
    ds_read_b64_tr_b16 v[38:39], v101 offset:10240
    buffer_load_dwordx4 v[184:187], v104, s[36:39], s0 offen offset:1024 sc1
    v_mfma_f32_16x16x32_bf16 v[68:71], v[52:55], v[136:139], v[68:71]
    ds_read_b64_tr_b16 v[40:41], v102 offset:8192
    ds_read_b64_tr_b16 v[42:43], v102 offset:10240
    v_mfma_f32_16x16x32_bf16 v[84:87], v[52:55], v[140:143], v[84:87]
    ds_read_b64_tr_b16 v[44:45], v103 offset:8192
    ds_read_b64_tr_b16 v[46:47], v103 offset:10240
    buffer_load_dwordx4 v[188:191], v105, s[36:39], s0 offen offset:1024 sc1
    v_mfma_f32_16x16x32_bf16 v[72:75], v[56:59], v[136:139], v[72:75]
    v_mfma_f32_16x16x32_bf16 v[88:91], v[56:59], v[140:143], v[88:91]
    s_add_u32 m0, s58, 40960
    s_lshl_b32 s1, s55, 17
    s_add_u32 s1, s1, s63
    s_add_u32 s1, s1, 0x10000
    buffer_load_dwordx4 v24, s[28:31], s1 offen lds
    v_mfma_f32_16x16x32_bf16 v[76:79], v[60:63], v[136:139], v[76:79]
    v_mfma_f32_16x16x32_bf16 v[92:95], v[60:63], v[140:143], v[92:95]
    s_add_u32 m0, s58, 41984
    s_add_u32 s1, s1, 8192
    buffer_load_dwordx4 v24, s[28:31], s1 offen lds
    s_waitcnt lgkmcnt(0)
    s_waitcnt vmcnt(15)
    v_mfma_f32_16x16x32_bf16 v[64:67], v[32:35], v[144:147], v[64:67]
    ds_read_b64_tr_b16 v[48:49], v100 offset:12288
    ds_read_b64_tr_b16 v[50:51], v100 offset:14336
    v_mfma_f32_16x16x32_bf16 v[80:83], v[32:35], v[148:151], v[80:83]
    ds_read_b64_tr_b16 v[52:53], v101 offset:12288
    ds_read_b64_tr_b16 v[54:55], v101 offset:14336
    s_lshl_b32 s0, s54, 12
    s_add_u32 s0, s0, s61
    buffer_load_dwordx4 v[192:195], v104, s[36:39], s0 offen offset:0 sc1
    v_mfma_f32_16x16x32_bf16 v[68:71], v[36:39], v[144:147], v[68:71]
    ds_read_b64_tr_b16 v[56:57], v102 offset:12288
    ds_read_b64_tr_b16 v[58:59], v102 offset:14336
    v_mfma_f32_16x16x32_bf16 v[84:87], v[36:39], v[148:151], v[84:87]
    ds_read_b64_tr_b16 v[60:61], v103 offset:12288
    ds_read_b64_tr_b16 v[62:63], v103 offset:14336
    buffer_load_dwordx4 v[196:199], v105, s[36:39], s0 offen offset:0 sc1
    v_mfma_f32_16x16x32_bf16 v[72:75], v[40:43], v[144:147], v[72:75]
    v_mfma_f32_16x16x32_bf16 v[88:91], v[40:43], v[148:151], v[88:91]
    s_add_u32 m0, s58, 49152
    s_lshl_b32 s1, s56, 17
    s_add_u32 s1, s1, s63
    s_add_u32 s1, s1, 0x10000
    buffer_load_dwordx4 v24, s[28:31], s1 offen lds
    v_mfma_f32_16x16x32_bf16 v[76:79], v[44:47], v[144:147], v[76:79]
    v_mfma_f32_16x16x32_bf16 v[92:95], v[44:47], v[148:151], v[92:95]
    s_add_u32 m0, s58, 50176
    s_add_u32 s1, s1, 8192
    buffer_load_dwordx4 v24, s[28:31], s1 offen lds
    s_waitcnt lgkmcnt(0)
    s_waitcnt vmcnt(17)
    v_mfma_f32_16x16x32_bf16 v[64:67], v[48:51], v[152:155], v[64:67]
    ds_read_b64_tr_b16 v[32:33], v100 offset:16384
    ds_read_b64_tr_b16 v[34:35], v100 offset:18432
    v_mfma_f32_16x16x32_bf16 v[80:83], v[48:51], v[156:159], v[80:83]
    ds_read_b64_tr_b16 v[36:37], v101 offset:16384
    ds_read_b64_tr_b16 v[38:39], v101 offset:18432
    buffer_load_dwordx4 v[200:203], v104, s[36:39], s0 offen offset:1024 sc1
    v_mfma_f32_16x16x32_bf16 v[68:71], v[52:55], v[152:155], v[68:71]
    ds_read_b64_tr_b16 v[40:41], v102 offset:16384
    ds_read_b64_tr_b16 v[42:43], v102 offset:18432
    v_mfma_f32_16x16x32_bf16 v[84:87], v[52:55], v[156:159], v[84:87]
    ds_read_b64_tr_b16 v[44:45], v103 offset:16384
    ds_read_b64_tr_b16 v[46:47], v103 offset:18432
    buffer_load_dwordx4 v[204:207], v105, s[36:39], s0 offen offset:1024 sc1
    v_mfma_f32_16x16x32_bf16 v[72:75], v[56:59], v[152:155], v[72:75]
    v_mfma_f32_16x16x32_bf16 v[88:91], v[56:59], v[156:159], v[88:91]
    v_mfma_f32_16x16x32_bf16 v[76:79], v[60:63], v[152:155], v[76:79]
    v_mfma_f32_16x16x32_bf16 v[92:95], v[60:63], v[156:159], v[92:95]
    s_waitcnt lgkmcnt(0)
    s_waitcnt vmcnt(17)
    v_mfma_f32_16x16x32_bf16 v[64:67], v[32:35], v[160:163], v[64:67]
    ds_read_b64_tr_b16 v[48:49], v100 offset:20480
    ds_read_b64_tr_b16 v[50:51], v100 offset:22528
    v_mfma_f32_16x16x32_bf16 v[80:83], v[32:35], v[164:167], v[80:83]
    ds_read_b64_tr_b16 v[52:53], v101 offset:20480
    ds_read_b64_tr_b16 v[54:55], v101 offset:22528
    s_lshl_b32 s0, s55, 12
    s_add_u32 s0, s0, s61
    buffer_load_dwordx4 v[208:211], v104, s[36:39], s0 offen offset:0 sc1
    v_mfma_f32_16x16x32_bf16 v[68:71], v[36:39], v[160:163], v[68:71]
    ds_read_b64_tr_b16 v[56:57], v102 offset:20480
    ds_read_b64_tr_b16 v[58:59], v102 offset:22528
    v_mfma_f32_16x16x32_bf16 v[84:87], v[36:39], v[164:167], v[84:87]
    ds_read_b64_tr_b16 v[60:61], v103 offset:20480
    ds_read_b64_tr_b16 v[62:63], v103 offset:22528
    buffer_load_dwordx4 v[212:215], v105, s[36:39], s0 offen offset:0 sc1
    v_mfma_f32_16x16x32_bf16 v[72:75], v[40:43], v[160:163], v[72:75]
    v_mfma_f32_16x16x32_bf16 v[88:91], v[40:43], v[164:167], v[88:91]
    v_mfma_f32_16x16x32_bf16 v[76:79], v[44:47], v[160:163], v[76:79]
    v_mfma_f32_16x16x32_bf16 v[92:95], v[44:47], v[164:167], v[92:95]
    s_waitcnt lgkmcnt(0)
    s_waitcnt vmcnt(17)
    v_mfma_f32_16x16x32_bf16 v[64:67], v[48:51], v[168:171], v[64:67]
    ds_read_b64_tr_b16 v[32:33], v100 offset:24576
    ds_read_b64_tr_b16 v[34:35], v100 offset:26624
    v_mfma_f32_16x16x32_bf16 v[80:83], v[48:51], v[172:175], v[80:83]
    ds_read_b64_tr_b16 v[36:37], v101 offset:24576
    ds_read_b64_tr_b16 v[38:39], v101 offset:26624
    buffer_load_dwordx4 v[216:219], v104, s[36:39], s0 offen offset:1024 sc1
    v_mfma_f32_16x16x32_bf16 v[68:71], v[52:55], v[168:171], v[68:71]
    ds_read_b64_tr_b16 v[40:41], v102 offset:24576
    ds_read_b64_tr_b16 v[42:43], v102 offset:26624
    v_mfma_f32_16x16x32_bf16 v[84:87], v[52:55], v[172:175], v[84:87]
    ds_read_b64_tr_b16 v[44:45], v103 offset:24576
    ds_read_b64_tr_b16 v[46:47], v103 offset:26624
    buffer_load_dwordx4 v[220:223], v105, s[36:39], s0 offen offset:1024 sc1
    v_mfma_f32_16x16x32_bf16 v[72:75], v[56:59], v[168:171], v[72:75]
    v_mfma_f32_16x16x32_bf16 v[88:91], v[56:59], v[172:175], v[88:91]
    v_mfma_f32_16x16x32_bf16 v[76:79], v[60:63], v[168:171], v[76:79]
    v_mfma_f32_16x16x32_bf16 v[92:95], v[60:63], v[172:175], v[92:95]
    s_waitcnt lgkmcnt(0)
    s_waitcnt vmcnt(16)
    v_mfma_f32_16x16x32_bf16 v[64:67], v[32:35], v[176:179], v[64:67]
    ds_read_b64_tr_b16 v[48:49], v100 offset:28672
    ds_read_b64_tr_b16 v[50:51], v100 offset:30720
    v_mfma_f32_16x16x32_bf16 v[80:83], v[32:35], v[180:183], v[80:83]
    ds_read_b64_tr_b16 v[52:53], v101 offset:28672
    ds_read_b64_tr_b16 v[54:55], v101 offset:30720
    s_lshl_b32 s0, s56, 12
    s_add_u32 s0, s0, s61
    buffer_load_dwordx4 v[224:227], v104, s[36:39], s0 offen offset:0 sc1
    v_mfma_f32_16x16x32_bf16 v[68:71], v[36:39], v[176:179], v[68:71]
    ds_read_b64_tr_b16 v[56:57], v102 offset:28672
    ds_read_b64_tr_b16 v[58:59], v102 offset:30720
    v_mfma_f32_16x16x32_bf16 v[84:87], v[36:39], v[180:183], v[84:87]
    ds_read_b64_tr_b16 v[60:61], v103 offset:28672
    ds_read_b64_tr_b16 v[62:63], v103 offset:30720
    buffer_load_dwordx4 v[228:231], v105, s[36:39], s0 offen offset:0 sc1
    v_mfma_f32_16x16x32_bf16 v[72:75], v[40:43], v[176:179], v[72:75]
    v_mfma_f32_16x16x32_bf16 v[88:91], v[40:43], v[180:183], v[88:91]
    v_mfma_f32_16x16x32_bf16 v[76:79], v[44:47], v[176:179], v[76:79]
    v_mfma_f32_16x16x32_bf16 v[92:95], v[44:47], v[180:183], v[92:95]
    s_waitcnt lgkmcnt(0)
    s_waitcnt vmcnt(14)
    v_mfma_f32_16x16x32_bf16 v[64:67], v[48:51], v[184:187], v[64:67]
    ds_read_b64_tr_b16 v[32:33], v100 offset:32768
    ds_read_b64_tr_b16 v[34:35], v100 offset:34816
    v_mfma_f32_16x16x32_bf16 v[80:83], v[48:51], v[188:191], v[80:83]
    ds_read_b64_tr_b16 v[36:37], v101 offset:32768
    ds_read_b64_tr_b16 v[38:39], v101 offset:34816
    buffer_load_dwordx4 v[232:235], v104, s[36:39], s0 offen offset:1024 sc1
    v_mfma_f32_16x16x32_bf16 v[68:71], v[52:55], v[184:187], v[68:71]
    ds_read_b64_tr_b16 v[40:41], v102 offset:32768
    ds_read_b64_tr_b16 v[42:43], v102 offset:34816
    v_mfma_f32_16x16x32_bf16 v[84:87], v[52:55], v[188:191], v[84:87]
    ds_read_b64_tr_b16 v[44:45], v103 offset:32768
    ds_read_b64_tr_b16 v[46:47], v103 offset:34816
    buffer_load_dwordx4 v[236:239], v105, s[36:39], s0 offen offset:1024 sc1
    v_mfma_f32_16x16x32_bf16 v[72:75], v[56:59], v[184:187], v[72:75]
    v_mfma_f32_16x16x32_bf16 v[88:91], v[56:59], v[188:191], v[88:91]
    v_mfma_f32_16x16x32_bf16 v[76:79], v[60:63], v[184:187], v[76:79]
    v_mfma_f32_16x16x32_bf16 v[92:95], v[60:63], v[188:191], v[92:95]
    s_waitcnt lgkmcnt(0)
    s_waitcnt vmcnt(12)
    s_add_u32 s62, s62, 0x8000
    buffer_load_dword v31, v106, s[36:39], s62 offen sc1
    v_mfma_f32_16x16x32_bf16 v[64:67], v[32:35], v[192:195], v[64:67]
    ds_read_b64_tr_b16 v[48:49], v100 offset:36864
    ds_read_b64_tr_b16 v[50:51], v100 offset:38912
    v_mfma_f32_16x16x32_bf16 v[80:83], v[32:35], v[196:199], v[80:83]
    ds_read_b64_tr_b16 v[52:53], v101 offset:36864
    ds_read_b64_tr_b16 v[54:55], v101 offset:38912
    v_mfma_f32_16x16x32_bf16 v[68:71], v[36:39], v[192:195], v[68:71]
    ds_read_b64_tr_b16 v[56:57], v102 offset:36864
    ds_read_b64_tr_b16 v[58:59], v102 offset:38912
    v_mfma_f32_16x16x32_bf16 v[84:87], v[36:39], v[196:199], v[84:87]
    ds_read_b64_tr_b16 v[60:61], v103 offset:36864
    ds_read_b64_tr_b16 v[62:63], v103 offset:38912
    v_mfma_f32_16x16x32_bf16 v[72:75], v[40:43], v[192:195], v[72:75]
    v_mfma_f32_16x16x32_bf16 v[88:91], v[40:43], v[196:199], v[88:91]
    v_mfma_f32_16x16x32_bf16 v[76:79], v[44:47], v[192:195], v[76:79]
    v_mfma_f32_16x16x32_bf16 v[92:95], v[44:47], v[196:199], v[92:95]
    s_waitcnt lgkmcnt(0)
    s_waitcnt vmcnt(0)
    v_cmp_ne_u32 vcc, v31, v5
    s_cmp_lg_u64 vcc, 0
    s_cbranch_scc1 L_slow1
L_back1:
    v_mfma_f32_16x16x32_bf16 v[64:67], v[48:51], v[200:203], v[64:67]
    ds_read_b64_tr_b16 v[32:33], v100 offset:40960
    ds_read_b64_tr_b16 v[34:35], v100 offset:43008
    v_mfma_f32_16x16x32_bf16 v[80:83], v[48:51], v[204:207], v[80:83]
    ds_read_b64_tr_b16 v[36:37], v101 offset:40960
    ds_read_b64_tr_b16 v[38:39], v101 offset:43008
    s_lshl_b32 s0, s50, 12
    s_add_u32 s0, s0, s61
    buffer_load_dwordx4 v[128:131], v104, s[36:39], s0 offen offset:2048 sc1
    v_mfma_f32_16x16x32_bf16 v[68:71], v[52:55], v[200:203], v[68:71]
    ds_read_b64_tr_b16 v[40:41], v102 offset:40960
    ds_read_b64_tr_b16 v[42:43], v102 offset:43008
    v_mfma_f32_16x16x32_bf16 v[84:87], v[52:55], v[204:207], v[84:87]
    ds_read_b64_tr_b16 v[44:45], v103 offset:40960
    ds_read_b64_tr_b16 v[46:47], v103 offset:43008
    buffer_load_dwordx4 v[132:135], v105, s[36:39], s0 offen offset:2048 sc1
    v_mfma_f32_16x16x32_bf16 v[72:75], v[56:59], v[200:203], v[72:75]
    v_mfma_f32_16x16x32_bf16 v[88:91], v[56:59], v[204:207], v[88:91]
    buffer_load_dwordx4 v[136:139], v104, s[36:39], s0 offen offset:3072 sc1
    v_mfma_f32_16x16x32_bf16 v[76:79], v[60:63], v[200:203], v[76:79]
    v_mfma_f32_16x16x32_bf16 v[92:95], v[60:63], v[204:207], v[92:95]
    buffer_load_dwordx4 v[140:143], v105, s[36:39], s0 offen offset:3072 sc1
    s_waitcnt lgkmcnt(0)
    v_mov_b32 v19, 1
    s_mov_b64 exec, 1
    ds_add_u32 v25, v19 offset:36
    s_mov_b64 exec, -1
    v_mfma_f32_16x16x32_bf16 v[64:67], v[32:35], v[208:211], v[64:67]
    ds_read_b64_tr_b16 v[48:49], v100 offset:45056
    ds_read_b64_tr_b16 v[50:51], v100 offset:47104
    v_mfma_f32_16x16x32_bf16 v[80:83], v[32:35], v[212:215], v[80:83]
    ds_read_b64_tr_b16 v[52:53], v101 offset:45056
    ds_read_b64_tr_b16 v[54:55], v101 offset:47104
    s_lshl_b32 s0, s51, 12
    s_add_u32 s0, s0, s61
    buffer_load_dwordx4 v[144:147], v104, s[36:39], s0 offen offset:2048 sc1
    v_mfma_f32_16x16x32_bf16 v[68:71], v[36:39], v[208:211], v[68:71]
    ds_read_b64_tr_b16 v[56:57], v102 offset:45056
    ds_read_b64_tr_b16 v[58:59], v102 offset:47104
    v_mfma_f32_16x16x32_bf16 v[84:87], v[36:39], v[212:215], v[84:87]
    ds_read_b64_tr_b16 v[60:61], v103 offset:45056
    ds_read_b64_tr_b16 v[62:63], v103 offset:47104
    buffer_load_dwordx4 v[148:151], v105, s[36:39], s0 offen offset:2048 sc1
    v_mfma_f32_16x16x32_bf16 v[72:75], v[40:43], v[208:211], v[72:75]
    v_mfma_f32_16x16x32_bf16 v[88:91], v[40:43], v[212:215], v[88:91]
    v_mfma_f32_16x16x32_bf16 v[76:79], v[44:47], v[208:211], v[76:79]
    v_mfma_f32_16x16x32_bf16 v[92:95], v[44:47], v[212:215], v[92:95]
    s_waitcnt lgkmcnt(0)
    v_mfma_f32_16x16x32_bf16 v[64:67], v[48:51], v[216:219], v[64:67]
    ds_read_b64_tr_b16 v[32:33], v100 offset:49152
    ds_read_b64_tr_b16 v[34:35], v100 offset:51200
    v_mfma_f32_16x16x32_bf16 v[80:83], v[48:51], v[220:223], v[80:83]
    ds_read_b64_tr_b16 v[36:37], v101 offset:49152
    ds_read_b64_tr_b16 v[38:39], v101 offset:51200
    buffer_load_dwordx4 v[152:155], v104, s[36:39], s0 offen offset:3072 sc1
    v_mfma_f32_16x16x32_bf16 v[68:71], v[52:55], v[216:219], v[68:71]
    ds_read_b64_tr_b16 v[40:41], v102 offset:49152
    ds_read_b64_tr_b16 v[42:43], v102 offset:51200
    v_mfma_f32_16x16x32_bf16 v[84:87], v[52:55], v[220:223], v[84:87]
    ds_read_b64_tr_b16 v[44:45], v103 offset:49152
    ds_read_b64_tr_b16 v[46:47], v103 offset:51200
    buffer_load_dwordx4 v[156:159], v105, s[36:39], s0 offen offset:3072 sc1
    v_mfma_f32_16x16x32_bf16 v[72:75], v[56:59], v[216:219], v[72:75]
    v_mfma_f32_16x16x32_bf16 v[88:91], v[56:59], v[220:223], v[88:91]
    v_mfma_f32_16x16x32_bf16 v[76:79], v[60:63], v[216:219], v[76:79]
    v_mfma_f32_16x16x32_bf16 v[92:95], v[60:63], v[220:223], v[92:95]
    s_waitcnt lgkmcnt(0)
    ds_read_b32 v107, v25 offset:36
    v_mov_b32 v19, 1
    s_mov_b64 exec, 1
    ds_add_u32 v25, v19 offset:20
    s_mov_b64 exec, -1
    v_mfma_f32_16x16x32_bf16 v[64:67], v[32:35], v[224:227], v[64:67]
    ds_read_b64_tr_b16 v[48:49], v100 offset:53248
    ds_read_b64_tr_b16 v[50:51], v100 offset:55296
    v_mfma_f32_16x16x32_bf16 v[80:83], v[32:35], v[228:231], v[80:83]
    ds_read_b64_tr_b16 v[52:53], v101 offset:53248
    ds_read_b64_tr_b16 v[54:55], v101 offset:55296
    s_lshl_b32 s0, s52, 12
    s_add_u32 s0, s0, s61
    buffer_load_dwordx4 v[160:163], v104, s[36:39], s0 offen offset:2048 sc1
    v_mfma_f32_16x16x32_bf16 v[68:71], v[36:39], v[224:227], v[68:71]
    ds_read_b64_tr_b16 v[56:57], v102 offset:53248
    ds_read_b64_tr_b16 v[58:59], v102 offset:55296
    v_mfma_f32_16x16x32_bf16 v[84:87], v[36:39], v[228:231], v[84:87]
    ds_read_b64_tr_b16 v[60:61], v103 offset:53248
    ds_read_b64_tr_b16 v[62:63], v103 offset:55296
    buffer_load_dwordx4 v[164:167], v105, s[36:39], s0 offen offset:2048 sc1
    v_mfma_f32_16x16x32_bf16 v[72:75], v[40:43], v[224:227], v[72:75]
    v_mfma_f32_16x16x32_bf16 v[88:91], v[40:43], v[228:231], v[88:91]
    v_mfma_f32_16x16x32_bf16 v[76:79], v[44:47], v[224:227], v[76:79]
    v_mfma_f32_16x16x32_bf16 v[92:95], v[44:47], v[228:231], v[92:95]
    s_waitcnt lgkmcnt(0)
    v_subrev_u32 v100, 0x10000, v100
    v_subrev_u32 v101, 0x10000, v101
    v_subrev_u32 v102, 0x10000, v102
    v_subrev_u32 v103, 0x10000, v103
    v_readfirstlane_b32 s43, v107
    s_cmp_lt_u32 s43, 4
    s_cbranch_scc1 L_gs9
L_gx9:
    v_mfma_f32_16x16x32_bf16 v[64:67], v[48:51], v[232:235], v[64:67]
    ds_read_b64_tr_b16 v[32:33], v100 offset:0
    ds_read_b64_tr_b16 v[34:35], v100 offset:2048
    v_mfma_f32_16x16x32_bf16 v[80:83], v[48:51], v[236:239], v[80:83]
    ds_read_b64_tr_b16 v[36:37], v101 offset:0
    ds_read_b64_tr_b16 v[38:39], v101 offset:2048
    buffer_load_dwordx4 v[168:171], v104, s[36:39], s0 offen offset:3072 sc1
    v_mfma_f32_16x16x32_bf16 v[68:71], v[52:55], v[232:235], v[68:71]
    ds_read_b64_tr_b16 v[40:41], v102 offset:0
    ds_read_b64_tr_b16 v[42:43], v102 offset:2048
    v_mfma_f32_16x16x32_bf16 v[84:87], v[52:55], v[236:239], v[84:87]
    ds_read_b64_tr_b16 v[44:45], v103 offset:0
    ds_read_b64_tr_b16 v[46:47], v103 offset:2048
    buffer_load_dwordx4 v[172:175], v105, s[36:39], s0 offen offset:3072 sc1
    v_mfma_f32_16x16x32_bf16 v[72:75], v[56:59], v[232:235], v[72:75]
    v_mfma_f32_16x16x32_bf16 v[88:91], v[56:59], v[236:239], v[88:91]
    v_mfma_f32_16x16x32_bf16 v[76:79], v[60:63], v[232:235], v[76:79]
    v_mfma_f32_16x16x32_bf16 v[92:95], v[60:63], v[236:239], v[92:95]
    s_waitcnt lgkmcnt(0)
    s_waitcnt vmcnt(10)
    v_mfma_f32_16x16x32_bf16 v[64:67], v[32:35], v[128:131], v[64:67]
    ds_read_b64_tr_b16 v[48:49], v100 offset:4096
    ds_read_b64_tr_b16 v[50:51], v100 offset:6144
    v_mfma_f32_16x16x32_bf16 v[80:83], v[32:35], v[132:135], v[80:83]
    ds_read_b64_tr_b16 v[52:53], v101 offset:4096
    ds_read_b64_tr_b16 v[54:55], v101 offset:6144
    s_lshl_b32 s0, s53, 12
    s_add_u32 s0, s0, s61
    buffer_load_dwordx4 v[176:179], v104, s[36:39], s0 offen offset:2048 sc1
    v_mfma_f32_16x16x32_bf16 v[68:71], v[36:39], v[128:131], v[68:71]
    ds_read_b64_tr_b16 v[56:57], v102 offset:4096
    ds_read_b64_tr_b16 v[58:59], v102 offset:6144
    v_mfma_f32_16x16x32_bf16 v[84:87], v[36:39], v[132:135], v[84:87]
    ds_read_b64_tr_b16 v[60:61], v103 offset:4096
    ds_read_b64_tr_b16 v[62:63], v103 offset:6144
    buffer_load_dwordx4 v[180:183], v105, s[36:39], s0 offen offset:2048 sc1
    v_mfma_f32_16x16x32_bf16 v[72:75], v[40:43], v[128:131], v[72:75]
    v_mfma_f32_16x16x32_bf16 v[88:91], v[40:43], v[132:135], v[88:91]
    v_mfma_f32_16x16x32_bf16 v[76:79], v[44:47], v[128:131], v[76:79]
    v_mfma_f32_16x16x32_bf16 v[92:95], v[44:47], v[132:135], v[92:95]
    s_waitcnt lgkmcnt(0)
    s_waitcnt vmcnt(10)
    v_mov_b32 v19, 1
    s_mov_b64 exec, 1
    ds_add_u32 v25, v19 offset:24
    s_mov_b64 exec, -1
    v_mfma_f32_16x16x32_bf16 v[64:67], v[48:51], v[136:139], v[64:67]
    ds_read_b64_tr_b16 v[32:33], v100 offset:8192
    ds_read_b64_tr_b16 v[34:35], v100 offset:10240
    v_mfma_f32_16x16x32_bf16 v[80:83], v[48:51], v[140:143], v[80:83]
    ds_read_b64_tr_b16 v[36:37], v101 offset:8192
    ds_read_b64_tr_b16 v[38:39], v101 offset:10240
    buffer_load_dwordx4 v[184:187], v104, s[36:39], s0 offen offset:3072 sc1
    v_mfma_f32_16x16x32_bf16 v[68:71], v[52:55], v[136:139], v[68:71]
    ds_read_b64_tr_b16 v[40:41], v102 offset:8192
    ds_read_b64_tr_b16 v[42:43], v102 offset:10240
    v_mfma_f32_16x16x32_bf16 v[84:87], v[52:55], v[140:143], v[84:87]
    ds_read_b64_tr_b16 v[44:45], v103 offset:8192
    ds_read_b64_tr_b16 v[46:47], v103 offset:10240
    buffer_load_dwordx4 v[188:191], v105, s[36:39], s0 offen offset:3072 sc1
    v_mfma_f32_16x16x32_bf16 v[72:75], v[56:59], v[136:139], v[72:75]
    v_mfma_f32_16x16x32_bf16 v[88:91], v[56:59], v[140:143], v[88:91]
    v_mfma_f32_16x16x32_bf16 v[76:79], v[60:63], v[136:139], v[76:79]
    v_mfma_f32_16x16x32_bf16 v[92:95], v[60:63], v[140:143], v[92:95]
    s_waitcnt lgkmcnt(0)
    s_waitcnt vmcnt(10)
    v_mfma_f32_16x16x32_bf16 v[64:67], v[32:35], v[144:147], v[64:67]
    ds_read_b64_tr_b16 v[48:49], v100 offset:12288
    ds_read_b64_tr_b16 v[50:51], v100 offset:14336
    v_mfma_f32_16x16x32_bf16 v[80:83], v[32:35], v[148:151], v[80:83]
    ds_read_b64_tr_b16 v[52:53], v101 offset:12288
    ds_read_b64_tr_b16 v[54:55], v101 offset:14336
    s_lshl_b32 s0, s54, 12
    s_add_u32 s0, s0, s61
    buffer_load_dwordx4 v[192:195], v104, s[36:39], s0 offen offset:2048 sc1
    v_mfma_f32_16x16x32_bf16 v[68:71], v[36:39], v[144:147], v[68:71]
    ds_read_b64_tr_b16 v[56:57], v102 offset:12288
    ds_read_b64_tr_b16 v[58:59], v102 offset:14336
    v_mfma_f32_16x16x32_bf16 v[84:87], v[36:39], v[148:151], v[84:87]
    ds_read_b64_tr_b16 v[60:61], v103 offset:12288
    ds_read_b64_tr_b16 v[62:63], v103 offset:14336
    buffer_load_dwordx4 v[196:199], v105, s[36:39], s0 offen offset:2048 sc1
    v_mfma_f32_16x16x32_bf16 v[72:75], v[40:43], v[144:147], v[72:75]
    v_mfma_f32_16x16x32_bf16 v[88:91], v[40:43], v[148:151], v[88:91]
    v_mfma_f32_16x16x32_bf16 v[76:79], v[44:47], v[144:147], v[76:79]
    v_mfma_f32_16x16x32_bf16 v[92:95], v[44:47], v[148:151], v[92:95]
    s_waitcnt lgkmcnt(0)
    s_waitcnt vmcnt(10)
    v_mfma_f32_16x16x32_bf16 v[64:67], v[48:51], v[152:155], v[64:67]
    ds_read_b64_tr_b16 v[32:33], v100 offset:16384
    ds_read_b64_tr_b16 v[34:35], v100 offset:18432
    v_mfma_f32_16x16x32_bf16 v[80:83], v[48:51], v[156:159], v[80:83]
    ds_read_b64_tr_b16 v[36:37], v101 offset:16384
    ds_read_b64_tr_b16 v[38:39], v101 offset:18432
    buffer_load_dwordx4 v[200:203], v104, s[36:39], s0 offen offset:3072 sc1
    v_mfma_f32_16x16x32_bf16 v[68:71], v[52:55], v[152:155], v[68:71]
    ds_read_b64_tr_b16 v[40:41], v102 offset:16384
    ds_read_b64_tr_b16 v[42:43], v102 offset:18432
    v_mfma_f32_16x16x32_bf16 v[84:87], v[52:55], v[156:159], v[84:87]
    ds_read_b64_tr_b16 v[44:45], v103 offset:16384
    ds_read_b64_tr_b16 v[46:47], v103 offset:18432
    buffer_load_dwordx4 v[204:207], v105, s[36:39], s0 offen offset:3072 sc1
    v_mfma_f32_16x16x32_bf16 v[72:75], v[56:59], v[152:155], v[72:75]
    v_mfma_f32_16x16x32_bf16 v[88:91], v[56:59], v[156:159], v[88:91]
    v_mfma_f32_16x16x32_bf16 v[76:79], v[60:63], v[152:155], v[76:79]
    v_mfma_f32_16x16x32_bf16 v[92:95], v[60:63], v[156:159], v[92:95]
    s_waitcnt lgkmcnt(0)
    s_waitcnt vmcnt(10)
    v_mfma_f32_16x16x32_bf16 v[64:67], v[32:35], v[160:163], v[64:67]
    ds_read_b64_tr_b16 v[48:49], v100 offset:20480
    ds_read_b64_tr_b16 v[50:51], v100 offset:22528
    v_mfma_f32_16x16x32_bf16 v[80:83], v[32:35], v[164:167], v[80:83]
    ds_read_b64_tr_b16 v[52:53], v101 offset:20480
    ds_read_b64_tr_b16 v[54:55], v101 offset:22528
    s_lshl_b32 s0, s55, 12
    s_add_u32 s0, s0, s61
    buffer_load_dwordx4 v[208:211], v104, s[36:39], s0 offen offset:2048 sc1
    v_mfma_f32_16x16x32_bf16 v[68:71], v[36:39], v[160:163], v[68:71]
    ds_read_b64_tr_b16 v[56:57], v102 offset:20480
    ds_read_b64_tr_b16 v[58:59], v102 offset:22528
    v_mfma_f32_16x16x32_bf16 v[84:87], v[36:39], v[164:167], v[84:87]
    ds_read_b64_tr_b16 v[60:61], v103 offset:20480
    ds_read_b64_tr_b16 v[62:63], v103 offset:22528
    buffer_load_dwordx4 v[212:215], v105, s[36:39], s0 offen offset:2048 sc1
    v_mfma_f32_16x16x32_bf16 v[72:75], v[40:43], v[160:163], v[72:75]
    v_mfma_f32_16x16x32_bf16 v[88:91], v[40:43], v[164:167], v[88:91]
    v_mfma_f32_16x16x32_bf16 v[76:79], v[44:47], v[160:163], v[76:79]
    v_mfma_f32_16x16x32_bf16 v[92:95], v[44:47], v[164:167], v[92:95]
    s_waitcnt lgkmcnt(0)
    s_waitcnt vmcnt(10)
    v_mfma_f32_16x16x32_bf16 v[64:67], v[48:51], v[168:171], v[64:67]
    ds_read_b64_tr_b16 v[32:33], v100 offset:24576
    ds_read_b64_tr_b16 v[34:35], v100 offset:26624
    v_mfma_f32_16x16x32_bf16 v[80:83], v[48:51], v[172:175], v[80:83]
    ds_read_b64_tr_b16 v[36:37], v101 offset:24576
    ds_read_b64_tr_b16 v[38:39], v101 offset:26624
    buffer_load_dwordx4 v[216:219], v104, s[36:39], s0 offen offset:3072 sc1
    v_mfma_f32_16x16x32_bf16 v[68:71], v[52:55], v[168:171], v[68:71]
    ds_read_b64_tr_b16 v[40:41], v102 offset:24576
    ds_read_b64_tr_b16 v[42:43], v102 offset:26624
    v_mfma_f32_16x16x32_bf16 v[84:87], v[52:55], v[172:175], v[84:87]
    ds_read_b64_tr_b16 v[44:45], v103 offset:24576
    ds_read_b64_tr_b16 v[46:47], v103 offset:26624
    buffer_load_dwordx4 v[220:223], v105, s[36:39], s0 offen offset:3072 sc1
    v_mfma_f32_16x16x32_bf16 v[72:75], v[56:59], v[168:171], v[72:75]
    v_mfma_f32_16x16x32_bf16 v[88:91], v[56:59], v[172:175], v[88:91]
    v_mfma_f32_16x16x32_bf16 v[76:79], v[60:63], v[168:171], v[76:79]
    v_mfma_f32_16x16x32_bf16 v[92:95], v[60:63], v[172:175], v[92:95]
    s_waitcnt lgkmcnt(0)
    s_waitcnt vmcnt(10)
    v_mov_b32 v129, v5
    v_mov_b32 v131, v5
    v_mov_b32 v133, v5
    v_mov_b32 v135, v5
    v_mfma_f32_16x16x32_bf16 v[64:67], v[32:35], v[176:179], v[64:67]
    ds_read_b64_tr_b16 v[48:49], v100 offset:28672
    ds_read_b64_tr_b16 v[50:51], v100 offset:30720
    v_mfma_f32_16x16x32_bf16 v[80:83], v[32:35], v[180:183], v[80:83]
    ds_read_b64_tr_b16 v[52:53], v101 offset:28672
    ds_read_b64_tr_b16 v[54:55], v101 offset:30720
    s_lshl_b32 s0, s56, 12
    s_add_u32 s0, s0, s61
    buffer_load_dwordx4 v[224:227], v104, s[36:39], s0 offen offset:2048 sc1
    v_mfma_f32_16x16x32_bf16 v[68:71], v[36:39], v[176:179], v[68:71]
    ds_read_b64_tr_b16 v[56:57], v102 offset:28672
    ds_read_b64_tr_b16 v[58:59], v102 offset:30720
    v_mfma_f32_16x16x32_bf16 v[84:87], v[36:39], v[180:183], v[84:87]
    ds_read_b64_tr_b16 v[60:61], v103 offset:28672
    ds_read_b64_tr_b16 v[62:63], v103 offset:30720
    buffer_load_dwordx4 v[228:231], v105, s[36:39], s0 offen offset:2048 sc1
    v_mfma_f32_16x16x32_bf16 v[72:75], v[40:43], v[176:179], v[72:75]
    v_mfma_f32_16x16x32_bf16 v[88:91], v[40:43], v[180:183], v[88:91]
    v_mfma_f32_16x16x32_bf16 v[76:79], v[44:47], v[176:179], v[76:79]
    v_mfma_f32_16x16x32_bf16 v[92:95], v[44:47], v[180:183], v[92:95]
    s_waitcnt lgkmcnt(0)
    s_waitcnt vmcnt(10)
    v_mov_b32 v137, v5
    v_mov_b32 v139, v5
    v_mov_b32 v141, v5
    v_mov_b32 v143, v5
    v_mfma_f32_16x16x32_bf16 v[64:67], v[48:51], v[184:187], v[64:67]
    ds_read_b64_tr_b16 v[32:33], v100 offset:32768
    ds_read_b64_tr_b16 v[34:35], v100 offset:34816
    v_mfma_f32_16x16x32_bf16 v[80:83], v[48:51], v[188:191], v[80:83]
    ds_read_b64_tr_b16 v[36:37], v101 offset:32768
    ds_read_b64_tr_b16 v[38:39], v101 offset:34816
    buffer_load_dwordx4 v[232:235], v104, s[36:39], s0 offen offset:3072 sc1
    v_mfma_f32_16x16x32_bf16 v[68:71], v[52:55], v[184:187], v[68:71]
    ds_read_b64_tr_b16 v[40:41], v102 offset:32768
    ds_read_b64_tr_b16 v[42:43], v102 offset:34816
    v_mfma_f32_16x16x32_bf16 v[84:87], v[52:55], v[188:191], v[84:87]
    ds_read_b64_tr_b16 v[44:45], v103 offset:32768
    ds_read_b64_tr_b16 v[46:47], v103 offset:34816
    buffer_load_dwordx4 v[236:239], v105, s[36:39], s0 offen offset:3072 sc1
    v_mfma_f32_16x16x32_bf16 v[72:75], v[56:59], v[184:187], v[72:75]
    v_mfma_f32_16x16x32_bf16 v[88:91], v[56:59], v[188:191], v[88:91]
    v_mfma_f32_16x16x32_bf16 v[76:79], v[60:63], v[184:187], v[76:79]
    v_mfma_f32_16x16x32_bf16 v[92:95], v[60:63], v[188:191], v[92:95]
    s_waitcnt lgkmcnt(0)
    s_waitcnt vmcnt(10)
    v_mfma_f32_16x16x32_bf16 v[64:67], v[32:35], v[192:195], v[64:67]
    ds_read_b64_tr_b16 v[48:49], v100 offset:36864
    ds_read_b64_tr_b16 v[50:51], v100 offset:38912
    v_mfma_f32_16x16x32_bf16 v[80:83], v[32:35], v[196:199], v[80:83]
    ds_read_b64_tr_b16 v[52:53], v101 offset:36864
    ds_read_b64_tr_b16 v[54:55], v101 offset:38912
    v_mfma_f32_16x16x32_bf16 v[68:71], v[36:39], v[192:195], v[68:71]
    ds_read_b64_tr_b16 v[56:57], v102 offset:36864
    ds_read_b64_tr_b16 v[58:59], v102 offset:38912
    v_mfma_f32_16x16x32_bf16 v[84:87], v[36:39], v[196:199], v[84:87]
    ds_read_b64_tr_b16 v[60:61], v103 offset:36864
    ds_read_b64_tr_b16 v[62:63], v103 offset:38912
    v_mfma_f32_16x16x32_bf16 v[72:75], v[40:43], v[192:195], v[72:75]
    v_mfma_f32_16x16x32_bf16 v[88:91], v[40:43], v[196:199], v[88:91]
    v_mfma_f32_16x16x32_bf16 v[76:79], v[44:47], v[192:195], v[76:79]
    v_mfma_f32_16x16x32_bf16 v[92:95], v[44:47], v[196:199], v[92:95]
    s_waitcnt lgkmcnt(0)
    s_waitcnt vmcnt(8)
    v_mfma_f32_16x16x32_bf16 v[64:67], v[48:51], v[200:203], v[64:67]
    ds_read_b64_tr_b16 v[32:33], v100 offset:40960
    ds_read_b64_tr_b16 v[34:35], v100 offset:43008
    v_mfma_f32_16x16x32_bf16 v[80:83], v[48:51], v[204:207], v[80:83]
    ds_read_b64_tr_b16 v[36:37], v101 offset:40960
    ds_read_b64_tr_b16 v[38:39], v101 offset:43008
    v_mfma_f32_16x16x32_bf16 v[68:71], v[52:55], v[200:203], v[68:71]
    ds_read_b64_tr_b16 v[40:41], v102 offset:40960
    ds_read_b64_tr_b16 v[42:43], v102 offset:43008
    v_mfma_f32_16x16x32_bf16 v[84:87], v[52:55], v[204:207], v[84:87]
    ds_read_b64_tr_b16 v[44:45], v103 offset:40960
    ds_read_b64_tr_b16 v[46:47], v103 offset:43008
    v_mfma_f32_16x16x32_bf16 v[72:75], v[56:59], v[200:203], v[72:75]
    v_mfma_f32_16x16x32_bf16 v[88:91], v[56:59], v[204:207], v[88:91]
    v_mfma_f32_16x16x32_bf16 v[76:79], v[60:63], v[200:203], v[76:79]
    v_mfma_f32_16x16x32_bf16 v[92:95], v[60:63], v[204:207], v[92:95]
    s_waitcnt lgkmcnt(0)
    s_waitcnt vmcnt(6)
    v_mfma_f32_16x16x32_bf16 v[64:67], v[32:35], v[208:211], v[64:67]
    ds_read_b64_tr_b16 v[48:49], v100 offset:45056
    ds_read_b64_tr_b16 v[50:51], v100 offset:47104
    v_mfma_f32_16x16x32_bf16 v[80:83], v[32:35], v[212:215], v[80:83]
    ds_read_b64_tr_b16 v[52:53], v101 offset:45056
    ds_read_b64_tr_b16 v[54:55], v101 offset:47104
    v_mfma_f32_16x16x32_bf16 v[68:71], v[36:39], v[208:211], v[68:71]
    ds_read_b64_tr_b16 v[56:57], v102 offset:45056
    ds_read_b64_tr_b16 v[58:59], v102 offset:47104
    v_mfma_f32_16x16x32_bf16 v[84:87], v[36:39], v[212:215], v[84:87]
    ds_read_b64_tr_b16 v[60:61], v103 offset:45056
    ds_read_b64_tr_b16 v[62:63], v103 offset:47104
    v_mfma_f32_16x16x32_bf16 v[72:75], v[40:43], v[208:211], v[72:75]
    v_mfma_f32_16x16x32_bf16 v[88:91], v[40:43], v[212:215], v[88:91]
    v_mfma_f32_16x16x32_bf16 v[76:79], v[44:47], v[208:211], v[76:79]
    v_mfma_f32_16x16x32_bf16 v[92:95], v[44:47], v[212:215], v[92:95]
    s_waitcnt lgkmcnt(0)
    s_waitcnt vmcnt(4)
    v_mfma_f32_16x16x32_bf16 v[64:67], v[48:51], v[216:219], v[64:67]
    ds_read_b64_tr_b16 v[32:33], v100 offset:49152
    ds_read_b64_tr_b16 v[34:35], v100 offset:51200
    v_mfma_f32_16x16x32_bf16 v[80:83], v[48:51], v[220:223], v[80:83]
    ds_read_b64_tr_b16 v[36:37], v101 offset:49152
    ds_read_b64_tr_b16 v[38:39], v101 offset:51200
    v_mfma_f32_16x16x32_bf16 v[68:71], v[52:55], v[216:219], v[68:71]
    ds_read_b64_tr_b16 v[40:41], v102 offset:49152
    ds_read_b64_tr_b16 v[42:43], v102 offset:51200
    v_mfma_f32_16x16x32_bf16 v[84:87], v[52:55], v[220:223], v[84:87]
    ds_read_b64_tr_b16 v[44:45], v103 offset:49152
    ds_read_b64_tr_b16 v[46:47], v103 offset:51200
    v_mfma_f32_16x16x32_bf16 v[72:75], v[56:59], v[216:219], v[72:75]
    v_mfma_f32_16x16x32_bf16 v[88:91], v[56:59], v[220:223], v[88:91]
    v_mfma_f32_16x16x32_bf16 v[76:79], v[60:63], v[216:219], v[76:79]
    v_mfma_f32_16x16x32_bf16 v[92:95], v[60:63], v[220:223], v[92:95]
    s_waitcnt lgkmcnt(0)
    s_waitcnt vmcnt(2)
    v_mfma_f32_16x16x32_bf16 v[64:67], v[32:35], v[224:227], v[64:67]
    ds_read_b64_tr_b16 v[48:49], v100 offset:53248
    ds_read_b64_tr_b16 v[50:51], v100 offset:55296
    v_mfma_f32_16x16x32_bf16 v[80:83], v[32:35], v[228:231], v[80:83]
    ds_read_b64_tr_b16 v[52:53], v101 offset:53248
    ds_read_b64_tr_b16 v[54:55], v101 offset:55296
    v_mfma_f32_16x16x32_bf16 v[68:71], v[36:39], v[224:227], v[68:71]
    ds_read_b64_tr_b16 v[56:57], v102 offset:53248
    ds_read_b64_tr_b16 v[58:59], v102 offset:55296
    v_mfma_f32_16x16x32_bf16 v[84:87], v[36:39], v[228:231], v[84:87]
    ds_read_b64_tr_b16 v[60:61], v103 offset:53248
    ds_read_b64_tr_b16 v[62:63], v103 offset:55296
    v_mfma_f32_16x16x32_bf16 v[72:75], v[40:43], v[224:227], v[72:75]
    v_mfma_f32_16x16x32_bf16 v[88:91], v[40:43], v[228:231], v[88:91]
    v_mfma_f32_16x16x32_bf16 v[76:79], v[44:47], v[224:227], v[76:79]
    v_mfma_f32_16x16x32_bf16 v[92:95], v[44:47], v[228:231], v[92:95]
    s_waitcnt lgkmcnt(0)
    s_waitcnt vmcnt(0)
    v_mfma_f32_16x16x32_bf16 v[64:67], v[48:51], v[232:235], v[64:67]
    v_mfma_f32_16x16x32_bf16 v[80:83], v[48:51], v[236:239], v[80:83]
    v_mfma_f32_16x16x32_bf16 v[68:71], v[52:55], v[232:235], v[68:71]
    v_mfma_f32_16x16x32_bf16 v[84:87], v[52:55], v[236:239], v[84:87]
    v_mfma_f32_16x16x32_bf16 v[72:75], v[56:59], v[232:235], v[72:75]
    v_mfma_f32_16x16x32_bf16 v[88:91], v[56:59], v[236:239], v[88:91]
    v_mfma_f32_16x16x32_bf16 v[76:79], v[60:63], v[232:235], v[76:79]
    v_mfma_f32_16x16x32_bf16 v[92:95], v[60:63], v[236:239], v[92:95]
    s_lshl2_add_u32 s44, s2, s3
    s_lshl_b32 s44, s44, 12
    s_add_u32 s44, s44, 0x1200000
    s_nop 0
    v_mov_b32 v19, 1
    s_mov_b64 exec, 1
    ds_add_u32 v25, v19 offset:40
    s_mov_b64 exec, -1
    v_cvt_pk_bf16_f32 v128, v80, v81
    v_cvt_pk_bf16_f32 v130, v82, v83
    buffer_store_dwordx4 v[128:131], v2, s[36:39], s44 offen offset:0 sc1
    v_cvt_pk_bf16_f32 v132, v84, v85
    v_cvt_pk_bf16_f32 v134, v86, v87
    buffer_store_dwordx4 v[132:135], v2, s[36:39], s44 offen offset:1024 sc1
    v_cvt_pk_bf16_f32 v136, v88, v89
    v_cvt_pk_bf16_f32 v138, v90, v91
    buffer_store_dwordx4 v[136:139], v2, s[36:39], s44 offen offset:2048 sc1
    v_cvt_pk_bf16_f32 v140, v92, v93
    v_cvt_pk_bf16_f32 v142, v94, v95
    buffer_store_dwordx4 v[140:143], v2, s[36:39], s44 offen offset:3072 sc1
    buffer_load_dwordx4 v[248:251], v0, s[12:15], s41 offen
    s_xor_b32 s44, s44, 0x4000
    s_lshl_b32 s47, s3, 12
    v_add_u32 v10, s47, v21
    v_xor_b32 v11, 64, v10
    v_xor_b32 v12, 128, v10
    v_xor_b32 v13, 192, v10
    ds_read_b32 v19, v25 offset:40
    s_waitcnt lgkmcnt(0)
    v_readfirstlane_b32 s43, v19
    s_cmp_lt_u32 s43, 4
    s_cbranch_scc1 L_gs10
L_gx10:
    s_waitcnt vmcnt(1)
    s_mov_b32 s49, 0
L_yx:
    buffer_load_dwordx4 v[160:163], v2, s[36:39], s44 offen offset:0 sc1
    buffer_load_dwordx4 v[164:167], v2, s[36:39], s44 offen offset:1024 sc1
    buffer_load_dwordx4 v[168:171], v2, s[36:39], s44 offen offset:2048 sc1
    buffer_load_dwordx4 v[172:175], v2, s[36:39], s44 offen offset:3072 sc1
    s_waitcnt vmcnt(0)
    v_min3_u32 v30, v161, v163, v5
    v_max3_u32 v31, v161, v163, v5
    v_min3_u32 v30, v165, v167, v30
    v_max3_u32 v31, v165, v167, v31
    v_min3_u32 v30, v169, v171, v30
    v_max3_u32 v31, v169, v171, v31
    v_min3_u32 v30, v173, v175, v30
    v_max3_u32 v31, v173, v175, v31
    v_cmp_ne_u32 vcc, v30, v31
    s_cmp_lg_u64 vcc, 0
    s_cbranch_scc1 L_yxs
L_yxb:
    s_bitcmp1_b32 s2, 0
    s_cselect_b64 vcc, -1, 0
    v_cndmask_b32 v120, v121, v123, vcc
    v_and_b32 v161, 0xffff0000, v160
    v_lshlrev_b32 v160, 16, v160
    v_and_b32 v163, 0xffff0000, v162
    v_lshlrev_b32 v162, 16, v162
    v_and_b32 v165, 0xffff0000, v164
    v_lshlrev_b32 v164, 16, v164
    v_and_b32 v167, 0xffff0000, v166
    v_lshlrev_b32 v166, 16, v166
    v_and_b32 v169, 0xffff0000, v168
    v_lshlrev_b32 v168, 16, v168
    v_and_b32 v171, 0xffff0000, v170
    v_lshlrev_b32 v170, 16, v170
    v_and_b32 v173, 0xffff0000, v172
    v_lshlrev_b32 v172, 16, v172
    v_and_b32 v175, 0xffff0000, v174
    v_lshlrev_b32 v174, 16, v174
    v_pk_add_f32 v[64:65], v[64:65], v[160:161]
    v_pk_add_f32 v[66:67], v[66:67], v[162:163]
    v_pk_add_f32 v[68:69], v[68:69], v[164:165]
    v_pk_add_f32 v[70:71], v[70:71], v[166:167]
    v_pk_add_f32 v[72:73], v[72:73], v[168:169]
    v_pk_add_f32 v[74:75], v[74:75], v[170:171]
    v_pk_add_f32 v[76:77], v[76:77], v[172:173]
    v_pk_add_f32 v[78:79], v[78:79], v[174:175]
    v_pk_mul_f32 v[64:65], v[64:65], v[120:121] op_sel_hi:[1,0]
    v_pk_mul_f32 v[66:67], v[66:67], v[120:121] op_sel_hi:[1,0]
    v_pk_mul_f32 v[68:69], v[68:69], v[120:121] op_sel_hi:[1,0]
    v_pk_mul_f32 v[70:71], v[70:71], v[120:121] op_sel_hi:[1,0]
    v_pk_mul_f32 v[72:73], v[72:73], v[120:121] op_sel_hi:[1,0]
    v_pk_mul_f32 v[74:75], v[74:75], v[120:121] op_sel_hi:[1,0]
    v_pk_mul_f32 v[76:77], v[76:77], v[120:121] op_sel_hi:[1,0]
    v_pk_mul_f32 v[78:79], v[78:79], v[120:121] op_sel_hi:[1,0]
    ds_write_b128 v10, v[64:67]
    ds_write_b128 v11, v[68:71]
    ds_write_b128 v12, v[72:75]
    ds_write_b128 v13, v[76:79]
L_final:
    s_waitcnt vmcnt(0) lgkmcnt(0)
    s_barrier
    v_add_u32 v10, 0x20000, v22
    v_add_u32 v11, 0x20000, v23
    ds_read_b128 v[192:195], v22
    ds_read_b128 v[196:199], v23
    ds_read_b128 v[224:227], v10
    ds_read_b128 v[228:231], v11
    v_lshlrev_b32 v240, 16, v248
    v_and_b32 v241, 0xffff0000, v248
    v_lshlrev_b32 v242, 16, v249
    v_and_b32 v243, 0xffff0000, v249
    v_lshlrev_b32 v244, 16, v250
    v_and_b32 v245, 0xffff0000, v250
    v_lshlrev_b32 v246, 16, v251
    v_and_b32 v247, 0xffff0000, v251
    s_waitcnt lgkmcnt(2)
    v_mul_f32 v232, 0xbfb8aa3b, v192
    v_mul_f32 v233, 0xbfb8aa3b, v193
    v_mul_f32 v234, 0xbfb8aa3b, v194
    v_mul_f32 v235, 0xbfb8aa3b, v195
    v_mul_f32 v236, 0xbfb8aa3b, v196
    v_mul_f32 v237, 0xbfb8aa3b, v197
    v_mul_f32 v238, 0xbfb8aa3b, v198
    v_mul_f32 v239, 0xbfb8aa3b, v199
    v_exp_f32 v232, v232
    v_exp_f32 v233, v233
    v_exp_f32 v234, v234
    v_exp_f32 v235, v235
    v_exp_f32 v236, v236
    v_exp_f32 v237, v237
    v_exp_f32 v238, v238
    v_exp_f32 v239, v239
    s_waitcnt lgkmcnt(0)
    v_mul_f32 v192, v192, v224
    v_mul_f32 v193, v193, v225
    v_mul_f32 v194, v194, v226
    v_mul_f32 v195, v195, v227
    v_mul_f32 v196, v196, v228
    v_mul_f32 v197, v197, v229
    v_mul_f32 v198, v198, v230
    v_mul_f32 v199, v199, v231
    v_add_f32 v232, 1.0, v232
    v_add_f32 v233, 1.0, v233
    v_add_f32 v234, 1.0, v234
    v_add_f32 v235, 1.0, v235
    v_add_f32 v236, 1.0, v236
    v_add_f32 v237, 1.0, v237
    v_add_f32 v238, 1.0, v238
    v_add_f32 v239, 1.0, v239
    v_rcp_f32 v232, v232
    v_rcp_f32 v233, v233
    v_rcp_f32 v234, v234
    v_rcp_f32 v235, v235
    v_rcp_f32 v236, v236
    v_rcp_f32 v237, v237
    v_rcp_f32 v238, v238
    v_rcp_f32 v239, v239
    s_nop 0
    v_fmac_f32 v240, v192, v232
    v_fmac_f32 v241, v193, v233
    v_fmac_f32 v242, v194, v234
    v_fmac_f32 v243, v195, v235
    v_fmac_f32 v244, v196, v236
    v_fmac_f32 v245, v197, v237
    v_fmac_f32 v246, v198, v238
    v_fmac_f32 v247, v199, v239
    v_cvt_pk_bf16_f32 v224, v240, v241
    v_cvt_pk_bf16_f32 v225, v242, v243
    v_cvt_pk_bf16_f32 v226, v244, v245
    v_cvt_pk_bf16_f32 v227, v246, v247
    buffer_store_dwordx4 v[224:227], v0, s[32:35], s41 offen sc1
    s_or_b32 s43, s2, s3
    s_or_b32 s43, s43, s7
    s_cbranch_scc1 L_noep
    s_mov_b32 s43, 0x40000
    s_mov_b64 exec, 1
    buffer_store_dword v5, off, s[36:39], s43 sc1
    s_mov_b64 exec, -1
L_noep:
L_done:
    s_endpgm
L_fft:
    s_lshl_b32 s43, s5, 5
    v_add_u32 v32, s43, v3
    v_lshrrev_b32 v33, 1, v32
    v_and_b32 v34, 1, v32
    v_cvt_f32_u32 v34, v34
    v_mul_f32 v34, 0x3e800000, v34
    v_cmp_eq_u32 vcc, 1, v32
    v_mov_b32 v35, 256
    s_lshl_b32 s43, s8, 6
    v_cndmask_b32 v33, v33, v35, vcc
    v_cndmask_b32 v34, v34, 0, vcc
    v_cvt_f32_u32 v33, v33
    v_mul_f32 v33, 0x3b000000, v33
    v_lshl_add_u32 v35, v4, 3, s43
    v_cvt_f32_u32 v35, v35
    v_fma_f32 v34, v35, v33, v34
    v_fract_f32 v40, v34
    v_mul_f32 v35, 0x42000000, v33
    v_fract_f32 v35, v35
    v_add_f32 v41, v40, v33
    v_add_f32 v42, v41, v33
    v_add_f32 v43, v42, v33
    v_add_f32 v44, v43, v33
    v_add_f32 v45, v44, v33
    v_add_f32 v46, v45, v33
    v_add_f32 v47, v46, v33
    v_cos_f32 v48, v40
    v_cos_f32 v49, v41
    v_cos_f32 v50, v42
    v_cos_f32 v51, v43
    v_cos_f32 v52, v44
    v_cos_f32 v53, v45
    v_cos_f32 v54, v46
    v_cos_f32 v55, v47
    v_add_f32 v40, v40, v35
    v_add_f32 v41, v41, v35
    v_add_f32 v42, v42, v35
    v_add_f32 v43, v43, v35
    v_add_f32 v44, v44, v35
    v_add_f32 v45, v45, v35
    v_add_f32 v46, v46, v35
    v_add_f32 v47, v47, v35
    v_cvt_pk_bf16_f32 v96, v48, v49
    v_cvt_pk_bf16_f32 v97, v50, v51
    v_cvt_pk_bf16_f32 v98, v52, v53
    v_cvt_pk_bf16_f32 v99, v54, v55
    v_cos_f32 v48, v40
    v_cos_f32 v49, v41
    v_cos_f32 v50, v42
    v_cos_f32 v51, v43
    v_cos_f32 v52, v44
    v_cos_f32 v53, v45
    v_cos_f32 v54, v46
    v_cos_f32 v55, v47
    v_add_f32 v40, v40, v35
    v_add_f32 v41, v41, v35
    v_add_f32 v42, v42, v35
    v_add_f32 v43, v43, v35
    v_add_f32 v44, v44, v35
    v_add_f32 v45, v45, v35
    v_add_f32 v46, v46, v35
    v_add_f32 v47, v47, v35
    v_cvt_pk_bf16_f32 v100, v48, v49
    v_cvt_pk_bf16_f32 v101, v50, v51
    v_cvt_pk_bf16_f32 v102, v52, v53
    v_cvt_pk_bf16_f32 v103, v54, v55
    v_cos_f32 v48, v40
    v_cos_f32 v49, v41
    v_cos_f32 v50, v42
    v_cos_f32 v51, v43
    v_cos_f32 v52, v44
    v_cos_f32 v53, v45
    v_cos_f32 v54, v46
    v_cos_f32 v55, v47
    v_add_f32 v40, v40, v35
    v_add_f32 v41, v41, v35
    v_add_f32 v42, v42, v35
    v_add_f32 v43, v43, v35
    v_add_f32 v44, v44, v35
    v_add_f32 v45, v45, v35
    v_add_f32 v46, v46, v35
    v_add_f32 v47, v47, v35
    v_cvt_pk_bf16_f32 v104, v48, v49
    v_cvt_pk_bf16_f32 v105, v50, v51
    v_cvt_pk_bf16_f32 v106, v52, v53
    v_cvt_pk_bf16_f32 v107, v54, v55
    v_cos_f32 v48, v40
    v_cos_f32 v49, v41
    v_cos_f32 v50, v42
    v_cos_f32 v51, v43
    v_cos_f32 v52, v44
    v_cos_f32 v53, v45
    v_cos_f32 v54, v46
    v_cos_f32 v55, v47
    s_nop 0
    v_cvt_pk_bf16_f32 v108, v48, v49
    v_cvt_pk_bf16_f32 v109, v50, v51
    v_cvt_pk_bf16_f32 v110, v52, v53
    v_cvt_pk_bf16_f32 v111, v54, v55
    s_waitcnt lgkmcnt(0)
    s_load_dword s9, s[36:37], 0x40000
    s_lshl_b32 s43, s5, 5
    v_add_u32 v32, s43, v3
    v_add_u32 v32, 16, v32
    v_lshrrev_b32 v33, 1, v32
    v_and_b32 v34, 1, v32
    v_cvt_f32_u32 v34, v34
    v_mul_f32 v34, 0x3e800000, v34
    s_lshl_b32 s43, s8, 6
    v_cvt_f32_u32 v33, v33
    v_mul_f32 v33, 0x3b000000, v33
    v_lshl_add_u32 v35, v4, 3, s43
    v_cvt_f32_u32 v35, v35
    v_fma_f32 v34, v35, v33, v34
    v_fract_f32 v40, v34
    v_mul_f32 v35, 0x42000000, v33
    v_fract_f32 v35, v35
    v_add_f32 v41, v40, v33
    v_add_f32 v42, v41, v33
    v_add_f32 v43, v42, v33
    v_add_f32 v44, v43, v33
    v_add_f32 v45, v44, v33
    v_add_f32 v46, v45, v33
    v_add_f32 v47, v46, v33
    v_cos_f32 v48, v40
    v_cos_f32 v49, v41
    v_cos_f32 v50, v42
    v_cos_f32 v51, v43
    v_cos_f32 v52, v44
    v_cos_f32 v53, v45
    v_cos_f32 v54, v46
    v_cos_f32 v55, v47
    v_add_f32 v40, v40, v35
    v_add_f32 v41, v41, v35
    v_add_f32 v42, v42, v35
    v_add_f32 v43, v43, v35
    v_add_f32 v44, v44, v35
    v_add_f32 v45, v45, v35
    v_add_f32 v46, v46, v35
    v_add_f32 v47, v47, v35
    v_cvt_pk_bf16_f32 v112, v48, v49
    v_cvt_pk_bf16_f32 v113, v50, v51
    v_cvt_pk_bf16_f32 v114, v52, v53
    v_cvt_pk_bf16_f32 v115, v54, v55
    v_cos_f32 v48, v40
    v_cos_f32 v49, v41
    v_cos_f32 v50, v42
    v_cos_f32 v51, v43
    v_cos_f32 v52, v44
    v_cos_f32 v53, v45
    v_cos_f32 v54, v46
    v_cos_f32 v55, v47
    v_add_f32 v40, v40, v35
    v_add_f32 v41, v41, v35
    v_add_f32 v42, v42, v35
    v_add_f32 v43, v43, v35
    v_add_f32 v44, v44, v35
    v_add_f32 v45, v45, v35
    v_add_f32 v46, v46, v35
    v_add_f32 v47, v47, v35
    v_cvt_pk_bf16_f32 v116, v48, v49
    v_cvt_pk_bf16_f32 v117, v50, v51
    v_cvt_pk_bf16_f32 v118, v52, v53
    v_cvt_pk_bf16_f32 v119, v54, v55
    v_cos_f32 v48, v40
    v_cos_f32 v49, v41
    v_cos_f32 v50, v42
    v_cos_f32 v51, v43
    v_cos_f32 v52, v44
    v_cos_f32 v53, v45
    v_cos_f32 v54, v46
    v_cos_f32 v55, v47
    v_add_f32 v40, v40, v35
    v_add_f32 v41, v41, v35
    v_add_f32 v42, v42, v35
    v_add_f32 v43, v43, v35
    v_add_f32 v44, v44, v35
    v_add_f32 v45, v45, v35
    v_add_f32 v46, v46, v35
    v_add_f32 v47, v47, v35
    v_cvt_pk_bf16_f32 v120, v48, v49
    v_cvt_pk_bf16_f32 v121, v50, v51
    v_cvt_pk_bf16_f32 v122, v52, v53
    v_cvt_pk_bf16_f32 v123, v54, v55
    v_cos_f32 v48, v40
    v_cos_f32 v49, v41
    v_cos_f32 v50, v42
    v_cos_f32 v51, v43
    v_cos_f32 v52, v44
    v_cos_f32 v53, v45
    v_cos_f32 v54, v46
    v_cos_f32 v55, v47
    s_nop 0
    v_cvt_pk_bf16_f32 v124, v48, v49
    v_cvt_pk_bf16_f32 v125, v50, v51
    v_cvt_pk_bf16_f32 v126, v52, v53
    v_cvt_pk_bf16_f32 v127, v54, v55
    v_bfe_u32 v19, v3, 1, 2
    v_cvt_f32_u32 v19, v19
    v_mul_f32 v19, 0x3e800000, v19
    v_cos_f32 v17, v19
    v_sin_f32 v18, v19
    v_bfe_u32 v16, v3, 1, 1
    v_mul_u32_u24 v16, 0x8000, v16
    v_lshl_or_b32 v16, v16, 16, v16
    v_rndne_f32 v17, v17
    v_rndne_f32 v18, v18
    v_lshlrev_b32 v19, 31, v3
    v_xor_b32 v18, v19, v18
    v_mov_b32 v224, 0x3f803f80
    v_mov_b32 v225, 0x3f803f80
    v_mov_b32 v226, 0x3f803f80
    v_mov_b32 v227, 0x3f803f80
    v_lshrrev_b32 v19, 1, v3
    v_xor_b32 v19, v19, v4
    v_lshlrev_b32 v19, 4, v19
    v_lshl_add_u32 v19, v3, 7, v19
    s_lshl_b32 s43, s3, 12
    v_add_u32 v26, s43, v19
    v_xor_b32 v27, 64, v26
    v_add_u32 v28, 0x10000, v26
    v_add_u32 v29, 0x10000, v27
    s_lshl_b32 s46, s3, 4
    v_add_u32 v56, s46, v3
    v_cvt_f32_u32 v59, v4
    v_cvt_f32_u32 v57, v56
    v_mul_f32 v59, 4.0, v59
    v_cvt_f32_u32 v60, v3
    v_and_b32 v62, 1, v3
    v_add_f32 v64, 0x00000000, v59
    v_add_f32 v65, 0x3f800000, v59
    v_add_f32 v66, 0x40000000, v59
    v_add_f32 v67, 0x40400000, v59
    v_add_f32 v68, 0x41800000, v59
    v_add_f32 v69, 0x41880000, v59
    v_add_f32 v70, 0x41900000, v59
    v_add_f32 v71, 0x41980000, v59
    v_mul_u32_u24 v62, 0x8000, v62
    v_mul_f32 v58, 0x3c800000, v57
    v_lshl_or_b32 v62, v62, 16, v62
    v_mul_f32 v32, v64, v58
    v_mul_f32 v33, v65, v58
    v_mul_f32 v34, v66, v58
    v_mul_f32 v35, v67, v58
    v_mul_f32 v36, v68, v58
    v_mul_f32 v37, v69, v58
    v_mul_f32 v38, v70, v58
    v_mul_f32 v39, v71, v58
    v_cos_f32 v40, v32
    v_cos_f32 v41, v33
    v_cos_f32 v42, v34
    v_cos_f32 v43, v35
    v_cos_f32 v44, v36
    v_cos_f32 v45, v37
    v_cos_f32 v46, v38
    v_cos_f32 v47, v39
    v_sin_f32 v48, v32
    v_sin_f32 v49, v33
    v_sin_f32 v50, v34
    v_sin_f32 v51, v35
    v_sin_f32 v52, v36
    v_sin_f32 v53, v37
    v_sin_f32 v54, v38
    v_sin_f32 v55, v39
    v_cvt_pk_bf16_f32 v128, v40, v41
    v_cvt_pk_bf16_f32 v129, v42, v43
    v_cvt_pk_bf16_f32 v130, v44, v45
    v_cvt_pk_bf16_f32 v131, v46, v47
    v_cvt_pk_bf16_f32 v136, v48, v49
    v_cvt_pk_bf16_f32 v137, v50, v51
    v_cvt_pk_bf16_f32 v138, v52, v53
    v_cvt_pk_bf16_f32 v139, v54, v55
    v_xor_b32 v132, v62, v128
    v_xor_b32 v133, v62, v129
    v_xor_b32 v134, v62, v130
    v_xor_b32 v135, v62, v131
    v_xor_b32 v140, v62, v136
    v_xor_b32 v141, v62, v137
    v_xor_b32 v142, v62, v138
    v_xor_b32 v143, v62, v139
    v_xor_b32 v144, 0x80008000, v136
    v_xor_b32 v145, 0x80008000, v137
    v_xor_b32 v146, 0x80008000, v138
    v_xor_b32 v147, 0x80008000, v139
    v_xor_b32 v148, 0x80008000, v140
    v_xor_b32 v149, 0x80008000, v141
    v_xor_b32 v150, 0x80008000, v142
    v_xor_b32 v151, 0x80008000, v143
    v_mul_f32 v61, 0x3d000000, v60
    v_mul_f32 v58, 0x3a000000, v57
    v_mul_f32 v32, v64, v61
    v_mul_f32 v33, v65, v61
    v_mul_f32 v34, v66, v61
    v_mul_f32 v35, v67, v61
    v_mul_f32 v36, v68, v61
    v_mul_f32 v37, v69, v61
    v_mul_f32 v38, v70, v61
    v_mul_f32 v39, v71, v61
    v_cos_f32 v40, v32
    v_cos_f32 v41, v33
    v_cos_f32 v42, v34
    v_cos_f32 v43, v35
    v_cos_f32 v44, v36
    v_cos_f32 v45, v37
    v_cos_f32 v46, v38
    v_cos_f32 v47, v39
    v_sin_f32 v48, v32
    v_sin_f32 v49, v33
    v_sin_f32 v50, v34
    v_sin_f32 v51, v35
    v_sin_f32 v52, v36
    v_sin_f32 v53, v37
    v_sin_f32 v54, v38
    v_sin_f32 v55, v39
    v_cvt_pk_bf16_f32 v152, v40, v41
    v_cvt_pk_bf16_f32 v153, v42, v43
    v_cvt_pk_bf16_f32 v154, v44, v45
    v_cvt_pk_bf16_f32 v155, v46, v47
    v_cvt_pk_bf16_f32 v160, v48, v49
    v_cvt_pk_bf16_f32 v161, v50, v51
    v_cvt_pk_bf16_f32 v162, v52, v53
    v_cvt_pk_bf16_f32 v163, v54, v55
    v_xor_b32 v156, 0x80000000, v152
    v_xor_b32 v157, 0x80000000, v153
    v_xor_b32 v158, 0x80000000, v154
    v_xor_b32 v159, 0x80000000, v155
    v_xor_b32 v164, 0x80000000, v160
    v_xor_b32 v165, 0x80000000, v161
    v_xor_b32 v166, 0x80000000, v162
    v_xor_b32 v167, 0x80000000, v163
    v_xor_b32 v168, 0x80008000, v160
    v_xor_b32 v169, 0x80008000, v161
    v_xor_b32 v170, 0x80008000, v162
    v_xor_b32 v171, 0x80008000, v163
    v_xor_b32 v172, 0x80008000, v164
    v_xor_b32 v173, 0x80008000, v165
    v_xor_b32 v174, 0x80008000, v166
    v_xor_b32 v175, 0x80008000, v167
    v_mul_f32 v32, v64, v58
    v_mul_f32 v33, v65, v58
    v_mul_f32 v34, v66, v58
    v_mul_f32 v35, v67, v58
    v_mul_f32 v36, v68, v58
    v_mul_f32 v37, v69, v58
    v_mul_f32 v38, v70, v58
    v_mul_f32 v39, v71, v58
    v_cvt_f32_u32 v61, s46
    v_cos_f32 v176, v32
    v_sin_f32 v184, v32
    v_cos_f32 v177, v33
    v_sin_f32 v185, v33
    v_cos_f32 v178, v34
    v_sin_f32 v186, v34
    v_cos_f32 v179, v35
    v_sin_f32 v187, v35
    v_cos_f32 v180, v36
    v_sin_f32 v188, v36
    v_cos_f32 v181, v37
    v_sin_f32 v189, v37
    v_cos_f32 v182, v38
    v_sin_f32 v190, v38
    v_cos_f32 v183, v39
    v_sin_f32 v191, v39
    v_mul_f32 v58, 0x3a000000, v60
    v_add_f32 v40, v61, v64
    v_add_f32 v41, v61, v65
    v_add_f32 v42, v61, v66
    v_add_f32 v43, v61, v67
    v_add_f32 v57, 0x3c000000, v58
    v_mul_f32 v32, v40, v58
    v_mul_f32 v33, v41, v58
    v_mul_f32 v34, v42, v58
    v_mul_f32 v35, v43, v58
    v_mul_f32 v36, v40, v57
    v_mul_f32 v37, v41, v57
    v_mul_f32 v38, v42, v57
    v_mul_f32 v39, v43, v57
    v_cos_f32 v192, v32
    v_sin_f32 v200, v32
    v_cos_f32 v193, v33
    v_sin_f32 v201, v33
    v_cos_f32 v194, v34
    v_sin_f32 v202, v34
    v_cos_f32 v195, v35
    v_sin_f32 v203, v35
    v_cos_f32 v196, v36
    v_sin_f32 v204, v36
    v_cos_f32 v197, v37
    v_sin_f32 v205, v37
    v_cos_f32 v198, v38
    v_sin_f32 v206, v38
    v_cos_f32 v199, v39
    v_sin_f32 v207, v39
    v_lshrrev_b32 v19, 2, v3
    v_lshl_add_u32 v20, v4, 3, v19
    v_lshlrev_b32 v20, 7, v20
    v_and_b32 v13, 1, v3
    v_lshl_add_u32 v20, v13, 3, v20
    v_bfe_u32 v19, v3, 3, 1
    v_and_b32 v13, 1, v4
    v_lshl_or_b32 v19, v13, 1, v19
    v_xor_b32 v19, s3, v19
    v_lshlrev_b32 v19, 1, v19
    v_bfe_u32 v13, v3, 1, 1
    v_or_b32 v19, v19, v13
    v_lshl_add_u32 v20, v19, 4, v20
    v_add_u32 v13, 0x10000, v20
    s_lshl_b32 s44, s3, 6
    s_add_u32 s44, s44, 0x26000
    v_lshl_add_u32 v231, v4, 4, s44
    v_lshrrev_b32 v7, 1, v3
    v_lshlrev_b32 v7, 13, v7
    v_and_b32 v19, 1, v3
    v_lshl_add_u32 v7, v19, 6, v7
    v_lshl_add_u32 v7, v4, 4, v7
    s_lshl_b32 s43, s3, 9
    s_add_u32 s43, s43, 0x26400
    v_lshl_add_u32 v8, v3, 2, s43
    v_lshl_add_u32 v9, v4, 4, s43
    s_lshl4_add_u32 s56, s5, s4
    s_lshl_b32 s56, s56, 7
    s_lshl2_add_u32 s56, s3, s56
    s_waitcnt lgkmcnt(0)
    s_add_u32 s9, s9, 0x9e3779b9
    v_mov_b32 v5, s9
    s_setprio 1
    s_barrier
    ds_read_b128 v[32:35], v28 offset:0
    ds_read_b128 v[36:39], v28 offset:2048
    ds_read_b128 v[40:43], v29 offset:0
    ds_read_b128 v[44:47], v29 offset:2048
    ds_read_b128 v[48:51], v28 offset:16384
    ds_read_b128 v[52:55], v28 offset:18432
    ds_read_b128 v[56:59], v29 offset:16384
    ds_read_b128 v[60:63], v29 offset:18432
    s_waitcnt lgkmcnt(6)
    v_mfma_f32_16x16x32_bf16 v[208:211], v[224:227], v[32:35], 0
    v_mfma_f32_16x16x32_bf16 v[216:219], v[32:35], v[32:35], 0
    v_mfma_f32_16x16x32_bf16 v[212:215], v[224:227], v[36:39], 0
    v_mfma_f32_16x16x32_bf16 v[220:223], v[36:39], v[36:39], 0
    v_mfma_f32_16x16x32_bf16 v[64:67], v[32:35], v[96:99], 0
    v_mfma_f32_16x16x32_bf16 v[80:83], v[32:35], v[112:115], 0
    v_mfma_f32_16x16x32_bf16 v[68:71], v[36:39], v[96:99], 0
    v_mfma_f32_16x16x32_bf16 v[84:87], v[36:39], v[112:115], 0
    s_waitcnt lgkmcnt(4)
    v_mfma_f32_16x16x32_bf16 v[208:211], v[224:227], v[40:43], v[208:211]
    v_mfma_f32_16x16x32_bf16 v[216:219], v[40:43], v[40:43], v[216:219]
    v_mfma_f32_16x16x32_bf16 v[212:215], v[224:227], v[44:47], v[212:215]
    v_mfma_f32_16x16x32_bf16 v[220:223], v[44:47], v[44:47], v[220:223]
    v_mfma_f32_16x16x32_bf16 v[64:67], v[40:43], v[100:103], v[64:67]
    v_mfma_f32_16x16x32_bf16 v[80:83], v[40:43], v[116:119], v[80:83]
    v_mfma_f32_16x16x32_bf16 v[68:71], v[44:47], v[100:103], v[68:71]
    v_mfma_f32_16x16x32_bf16 v[84:87], v[44:47], v[116:119], v[84:87]
    s_waitcnt lgkmcnt(2)
    v_mfma_f32_16x16x32_bf16 v[208:211], v[224:227], v[48:51], v[208:211]
    v_mfma_f32_16x16x32_bf16 v[216:219], v[48:51], v[48:51], v[216:219]
    v_mfma_f32_16x16x32_bf16 v[212:215], v[224:227], v[52:55], v[212:215]
    v_mfma_f32_16x16x32_bf16 v[220:223], v[52:55], v[52:55], v[220:223]
    v_mfma_f32_16x16x32_bf16 v[64:67], v[48:51], v[104:107], v[64:67]
    v_mfma_f32_16x16x32_bf16 v[80:83], v[48:51], v[120:123], v[80:83]
    v_mfma_f32_16x16x32_bf16 v[68:71], v[52:55], v[104:107], v[68:71]
    v_mfma_f32_16x16x32_bf16 v[84:87], v[52:55], v[120:123], v[84:87]
    s_waitcnt lgkmcnt(0)
    v_mfma_f32_16x16x32_bf16 v[208:211], v[224:227], v[56:59], v[208:211]
    v_mfma_f32_16x16x32_bf16 v[216:219], v[56:59], v[56:59], v[216:219]
    v_mfma_f32_16x16x32_bf16 v[212:215], v[224:227], v[60:63], v[212:215]
    v_mfma_f32_16x16x32_bf16 v[220:223], v[60:63], v[60:63], v[220:223]
    v_mfma_f32_16x16x32_bf16 v[64:67], v[56:59], v[108:111], v[64:67]
    v_mfma_f32_16x16x32_bf16 v[80:83], v[56:59], v[124:127], v[80:83]
    v_mfma_f32_16x16x32_bf16 v[68:71], v[60:63], v[108:111], v[68:71]
    v_mfma_f32_16x16x32_bf16 v[84:87], v[60:63], v[124:127], v[84:87]
    s_barrier
    ds_read_b128 v[32:35], v28 offset:32768
    ds_read_b128 v[36:39], v28 offset:34816
    ds_read_b128 v[40:43], v29 offset:32768
    ds_read_b128 v[44:47], v29 offset:34816
    ds_read_b128 v[48:51], v28 offset:49152
    ds_read_b128 v[52:55], v28 offset:51200
    ds_read_b128 v[56:59], v29 offset:49152
    ds_read_b128 v[60:63], v29 offset:51200
    s_waitcnt lgkmcnt(6)
    v_mfma_f32_16x16x32_bf16 v[208:211], v[224:227], v[32:35], v[208:211]
    v_mfma_f32_16x16x32_bf16 v[216:219], v[32:35], v[32:35], v[216:219]
    v_mfma_f32_16x16x32_bf16 v[212:215], v[224:227], v[36:39], v[212:215]
    v_mfma_f32_16x16x32_bf16 v[220:223], v[36:39], v[36:39], v[220:223]
    v_mfma_f32_16x16x32_bf16 v[72:75], v[32:35], v[96:99], 0
    v_mfma_f32_16x16x32_bf16 v[88:91], v[32:35], v[112:115], 0
    v_mfma_f32_16x16x32_bf16 v[76:79], v[36:39], v[96:99], 0
    v_mfma_f32_16x16x32_bf16 v[92:95], v[36:39], v[112:115], 0
    s_waitcnt lgkmcnt(4)
    v_mfma_f32_16x16x32_bf16 v[208:211], v[224:227], v[40:43], v[208:211]
    v_mfma_f32_16x16x32_bf16 v[216:219], v[40:43], v[40:43], v[216:219]
    v_mfma_f32_16x16x32_bf16 v[212:215], v[224:227], v[44:47], v[212:215]
    v_mfma_f32_16x16x32_bf16 v[220:223], v[44:47], v[44:47], v[220:223]
    v_mfma_f32_16x16x32_bf16 v[72:75], v[40:43], v[100:103], v[72:75]
    v_mfma_f32_16x16x32_bf16 v[88:91], v[40:43], v[116:119], v[88:91]
    v_mfma_f32_16x16x32_bf16 v[76:79], v[44:47], v[100:103], v[76:79]
    v_mfma_f32_16x16x32_bf16 v[92:95], v[44:47], v[116:119], v[92:95]
    s_waitcnt lgkmcnt(2)
    v_mfma_f32_16x16x32_bf16 v[208:211], v[224:227], v[48:51], v[208:211]
    v_mfma_f32_16x16x32_bf16 v[216:219], v[48:51], v[48:51], v[216:219]
    v_mfma_f32_16x16x32_bf16 v[212:215], v[224:227], v[52:55], v[212:215]
    v_mfma_f32_16x16x32_bf16 v[220:223], v[52:55], v[52:55], v[220:223]
    v_mfma_f32_16x16x32_bf16 v[72:75], v[48:51], v[104:107], v[72:75]
    v_mfma_f32_16x16x32_bf16 v[88:91], v[48:51], v[120:123], v[88:91]
    v_mfma_f32_16x16x32_bf16 v[76:79], v[52:55], v[104:107], v[76:79]
    v_mfma_f32_16x16x32_bf16 v[92:95], v[52:55], v[120:123], v[92:95]
    s_waitcnt lgkmcnt(0)
    v_mfma_f32_16x16x32_bf16 v[208:211], v[224:227], v[56:59], v[208:211]
    v_mfma_f32_16x16x32_bf16 v[216:219], v[56:59], v[56:59], v[216:219]
    v_mfma_f32_16x16x32_bf16 v[212:215], v[224:227], v[60:63], v[212:215]
    v_mfma_f32_16x16x32_bf16 v[220:223], v[60:63], v[60:63], v[220:223]
    v_mfma_f32_16x16x32_bf16 v[72:75], v[56:59], v[108:111], v[72:75]
    v_mfma_f32_16x16x32_bf16 v[88:91], v[56:59], v[124:127], v[88:91]
    v_mfma_f32_16x16x32_bf16 v[76:79], v[60:63], v[108:111], v[76:79]
    v_mfma_f32_16x16x32_bf16 v[92:95], v[60:63], v[124:127], v[92:95]
    s_barrier
    ds_read_b128 v[32:35], v26 offset:0
    ds_read_b128 v[36:39], v26 offset:2048
    ds_read_b128 v[40:43], v27 offset:0
    ds_read_b128 v[44:47], v27 offset:2048
    ds_read_b128 v[48:51], v26 offset:16384
    ds_read_b128 v[52:55], v26 offset:18432
    ds_read_b128 v[56:59], v27 offset:16384
    ds_read_b128 v[60:63], v27 offset:18432
    v_xor_b32 v96, v16, v96
    v_xor_b32 v97, v16, v97
    v_xor_b32 v98, v16, v98
    v_xor_b32 v99, v16, v99
    v_xor_b32 v100, v16, v100
    v_xor_b32 v101, v16, v101
    v_xor_b32 v102, v16, v102
    v_xor_b32 v103, v16, v103
    v_xor_b32 v104, v16, v104
    v_xor_b32 v105, v16, v105
    v_xor_b32 v106, v16, v106
    v_xor_b32 v107, v16, v107
    v_xor_b32 v108, v16, v108
    v_xor_b32 v109, v16, v109
    v_xor_b32 v110, v16, v110
    v_xor_b32 v111, v16, v111
    v_xor_b32 v112, v16, v112
    v_xor_b32 v113, v16, v113
    v_xor_b32 v114, v16, v114
    v_xor_b32 v115, v16, v115
    v_xor_b32 v116, v16, v116
    v_xor_b32 v117, v16, v117
    v_xor_b32 v118, v16, v118
    v_xor_b32 v119, v16, v119
    v_xor_b32 v120, v16, v120
    v_xor_b32 v121, v16, v121
    v_xor_b32 v122, v16, v122
    v_xor_b32 v123, v16, v123
    v_xor_b32 v124, v16, v124
    v_xor_b32 v125, v16, v125
    v_xor_b32 v126, v16, v126
    v_xor_b32 v127, v16, v127
    s_waitcnt lgkmcnt(6)
    v_mfma_f32_16x16x32_bf16 v[208:211], v[224:227], v[32:35], v[208:211]
    v_mfma_f32_16x16x32_bf16 v[216:219], v[32:35], v[32:35], v[216:219]
    v_mfma_f32_16x16x32_bf16 v[212:215], v[224:227], v[36:39], v[212:215]
    v_mfma_f32_16x16x32_bf16 v[220:223], v[36:39], v[36:39], v[220:223]
    v_mfma_f32_16x16x32_bf16 v[64:67], v[32:35], v[96:99], v[64:67]
    v_mfma_f32_16x16x32_bf16 v[80:83], v[32:35], v[112:115], v[80:83]
    v_mfma_f32_16x16x32_bf16 v[68:71], v[36:39], v[96:99], v[68:71]
    v_mfma_f32_16x16x32_bf16 v[84:87], v[36:39], v[112:115], v[84:87]
    s_waitcnt lgkmcnt(4)
    v_mfma_f32_16x16x32_bf16 v[208:211], v[224:227], v[40:43], v[208:211]
    v_mfma_f32_16x16x32_bf16 v[216:219], v[40:43], v[40:43], v[216:219]
    v_mfma_f32_16x16x32_bf16 v[212:215], v[224:227], v[44:47], v[212:215]
    v_mfma_f32_16x16x32_bf16 v[220:223], v[44:47], v[44:47], v[220:223]
    v_mfma_f32_16x16x32_bf16 v[64:67], v[40:43], v[100:103], v[64:67]
    v_mfma_f32_16x16x32_bf16 v[80:83], v[40:43], v[116:119], v[80:83]
    v_mfma_f32_16x16x32_bf16 v[68:71], v[44:47], v[100:103], v[68:71]
    v_mfma_f32_16x16x32_bf16 v[84:87], v[44:47], v[116:119], v[84:87]
    s_waitcnt lgkmcnt(2)
    v_mfma_f32_16x16x32_bf16 v[208:211], v[224:227], v[48:51], v[208:211]
    v_mfma_f32_16x16x32_bf16 v[216:219], v[48:51], v[48:51], v[216:219]
    v_mfma_f32_16x16x32_bf16 v[212:215], v[224:227], v[52:55], v[212:215]
    v_mfma_f32_16x16x32_bf16 v[220:223], v[52:55], v[52:55], v[220:223]
    v_mfma_f32_16x16x32_bf16 v[64:67], v[48:51], v[104:107], v[64:67]
    v_mfma_f32_16x16x32_bf16 v[80:83], v[48:51], v[120:123], v[80:83]
    v_mfma_f32_16x16x32_bf16 v[68:71], v[52:55], v[104:107], v[68:71]
    v_mfma_f32_16x16x32_bf16 v[84:87], v[52:55], v[120:123], v[84:87]
    s_waitcnt lgkmcnt(0)
    v_mfma_f32_16x16x32_bf16 v[208:211], v[224:227], v[56:59], v[208:211]
    v_mfma_f32_16x16x32_bf16 v[216:219], v[56:59], v[56:59], v[216:219]
    v_mfma_f32_16x16x32_bf16 v[212:215], v[224:227], v[60:63], v[212:215]
    v_mfma_f32_16x16x32_bf16 v[220:223], v[60:63], v[60:63], v[220:223]
    v_mfma_f32_16x16x32_bf16 v[64:67], v[56:59], v[108:111], v[64:67]
    v_mfma_f32_16x16x32_bf16 v[80:83], v[56:59], v[124:127], v[80:83]
    v_mfma_f32_16x16x32_bf16 v[68:71], v[60:63], v[108:111], v[68:71]
    v_mfma_f32_16x16x32_bf16 v[84:87], v[60:63], v[124:127], v[84:87]
    s_barrier
    ds_read_b128 v[32:35], v26 offset:32768
    ds_read_b128 v[36:39], v26 offset:34816
    ds_read_b128 v[40:43], v27 offset:32768
    ds_read_b128 v[44:47], v27 offset:34816
    ds_read_b128 v[48:51], v26 offset:49152
    ds_read_b128 v[52:55], v26 offset:51200
    ds_read_b128 v[56:59], v27 offset:49152
    ds_read_b128 v[60:63], v27 offset:51200
    s_waitcnt lgkmcnt(6)
    v_mfma_f32_16x16x32_bf16 v[208:211], v[224:227], v[32:35], v[208:211]
    v_mfma_f32_16x16x32_bf16 v[216:219], v[32:35], v[32:35], v[216:219]
    v_mfma_f32_16x16x32_bf16 v[212:215], v[224:227], v[36:39], v[212:215]
    v_mfma_f32_16x16x32_bf16 v[220:223], v[36:39], v[36:39], v[220:223]
    v_mfma_f32_16x16x32_bf16 v[72:75], v[32:35], v[96:99], v[72:75]
    v_mfma_f32_16x16x32_bf16 v[88:91], v[32:35], v[112:115], v[88:91]
    v_mfma_f32_16x16x32_bf16 v[76:79], v[36:39], v[96:99], v[76:79]
    v_mfma_f32_16x16x32_bf16 v[92:95], v[36:39], v[112:115], v[92:95]
    s_waitcnt lgkmcnt(4)
    v_mfma_f32_16x16x32_bf16 v[208:211], v[224:227], v[40:43], v[208:211]
    v_mfma_f32_16x16x32_bf16 v[216:219], v[40:43], v[40:43], v[216:219]
    v_mfma_f32_16x16x32_bf16 v[212:215], v[224:227], v[44:47], v[212:215]
    v_mfma_f32_16x16x32_bf16 v[220:223], v[44:47], v[44:47], v[220:223]
    v_mfma_f32_16x16x32_bf16 v[72:75], v[40:43], v[100:103], v[72:75]
    v_mfma_f32_16x16x32_bf16 v[88:91], v[40:43], v[116:119], v[88:91]
    v_mfma_f32_16x16x32_bf16 v[76:79], v[44:47], v[100:103], v[76:79]
    v_mfma_f32_16x16x32_bf16 v[92:95], v[44:47], v[116:119], v[92:95]
    s_waitcnt lgkmcnt(2)
    v_mfma_f32_16x16x32_bf16 v[208:211], v[224:227], v[48:51], v[208:211]
    v_mfma_f32_16x16x32_bf16 v[216:219], v[48:51], v[48:51], v[216:219]
    v_mfma_f32_16x16x32_bf16 v[212:215], v[224:227], v[52:55], v[212:215]
    v_mfma_f32_16x16x32_bf16 v[220:223], v[52:55], v[52:55], v[220:223]
    v_mfma_f32_16x16x32_bf16 v[72:75], v[48:51], v[104:107], v[72:75]
    v_mfma_f32_16x16x32_bf16 v[88:91], v[48:51], v[120:123], v[88:91]
    v_mfma_f32_16x16x32_bf16 v[76:79], v[52:55], v[104:107], v[76:79]
    v_mfma_f32_16x16x32_bf16 v[92:95], v[52:55], v[120:123], v[92:95]
    s_waitcnt lgkmcnt(0)
    v_mfma_f32_16x16x32_bf16 v[208:211], v[224:227], v[56:59], v[208:211]
    v_mfma_f32_16x16x32_bf16 v[216:219], v[56:59], v[56:59], v[216:219]
    v_mfma_f32_16x16x32_bf16 v[212:215], v[224:227], v[60:63], v[212:215]
    v_mfma_f32_16x16x32_bf16 v[220:223], v[60:63], v[60:63], v[220:223]
    v_mfma_f32_16x16x32_bf16 v[72:75], v[56:59], v[108:111], v[72:75]
    v_mfma_f32_16x16x32_bf16 v[88:91], v[56:59], v[124:127], v[88:91]
    v_mfma_f32_16x16x32_bf16 v[76:79], v[60:63], v[108:111], v[76:79]
    v_mfma_f32_16x16x32_bf16 v[92:95], v[60:63], v[124:127], v[92:95]
    s_barrier
    s_setprio 0
    v_and_b32 v19, 3, v3
    s_nop 1
    v_cmp_eq_u32 vcc, 1, v19
    s_nop 1
    v_cndmask_b32 v216, v216, v217, vcc
    v_cndmask_b32 v220, v220, v221, vcc
    v_cmp_eq_u32 vcc, 2, v19
    s_nop 1
    v_cndmask_b32 v216, v216, v218, vcc
    v_cndmask_b32 v220, v220, v222, vcc
    v_cmp_eq_u32 vcc, 3, v19
    s_nop 1
    v_cndmask_b32 v216, v216, v219, vcc
    v_cndmask_b32 v220, v220, v223, vcc
    v_mul_f32 v208, 0x3b000000, v208
    v_mul_f32 v212, 0x3b000000, v212
    v_mul_f32 v216, 0x3b000000, v216
    v_mul_f32 v220, 0x3b000000, v220
    v_fma_f32 v216, -v208, v208, v216
    v_fma_f32 v220, -v212, v212, v220
    v_max_f32 v216, 0, v216
    v_max_f32 v220, 0, v220
    v_cvt_pk_bf16_f32 v216, v216, v216
    v_cvt_pk_bf16_f32 v220, v220, v220
    v_lshlrev_b32 v216, 16, v216
    v_lshlrev_b32 v220, 16, v220
    v_add_f32 v216, 0x3727c5ac, v216
    v_add_f32 v220, 0x3727c5ac, v220
    v_cvt_pk_bf16_f32 v216, v216, v216
    v_cvt_pk_bf16_f32 v220, v220, v220
    v_lshlrev_b32 v216, 16, v216
    v_lshlrev_b32 v220, 16, v220
    v_sqrt_f32 v216, v216
    v_sqrt_f32 v220, v220
    v_sub_f32 v210, 0, v208
    v_sub_f32 v214, 0, v212
    v_cvt_pk_bf16_f32 v216, v216, v216
    v_cvt_pk_bf16_f32 v220, v220, v220
    v_lshlrev_b32 v216, 16, v216
    v_lshlrev_b32 v220, 16, v220
    v_rcp_f32 v209, v216
    v_rcp_f32 v213, v220
    v_cvt_pk_bf16_f32 v210, v210, v210
    v_cvt_pk_bf16_f32 v214, v214, v214
    v_lshlrev_b32 v210, 16, v210
    v_lshlrev_b32 v214, 16, v214
    v_add_f32 v211, v208, v210
    v_add_f32 v215, v212, v214
    v_mul_f32 v211, 0x44000000, v211
    v_mul_f32 v215, 0x44000000, v215
    s_mov_b32 exec_lo, 0x00f0000f
    s_mov_b32 exec_hi, 0xf0000f00
    ds_write2_b32 v8, v209, v210 offset0:0 offset1:32
    ds_write_b32 v8, v211 offset:256
    ds_write2_b32 v8, v213, v214 offset0:16 offset1:48
    ds_write_b32 v8, v215 offset:320
    s_mov_b64 exec, -1
    ds_read_b128 v[32:35], v9 offset:0
    ds_read_b128 v[40:43], v9 offset:256
    ds_read_b128 v[36:39], v9 offset:64
    ds_read_b128 v[44:47], v9 offset:320
    v_fmac_f32 v64, v17, v72
    v_fmac_f32 v65, v17, v73
    v_fmac_f32 v66, v17, v74
    v_fmac_f32 v67, v17, v75
    v_fmac_f32 v68, v17, v76
    v_fmac_f32 v69, v17, v77
    v_fmac_f32 v70, v17, v78
    v_fmac_f32 v71, v17, v79
    v_fmac_f32_dpp v64, v72, v18 quad_perm:[1,0,3,2] row_mask:0xf bank_mask:0xf
    v_fmac_f32_dpp v65, v73, v18 quad_perm:[1,0,3,2] row_mask:0xf bank_mask:0xf
    v_fmac_f32_dpp v66, v74, v18 quad_perm:[1,0,3,2] row_mask:0xf bank_mask:0xf
    v_fmac_f32_dpp v67, v75, v18 quad_perm:[1,0,3,2] row_mask:0xf bank_mask:0xf
    v_fmac_f32_dpp v68, v76, v18 quad_perm:[1,0,3,2] row_mask:0xf bank_mask:0xf
    v_fmac_f32_dpp v69, v77, v18 quad_perm:[1,0,3,2] row_mask:0xf bank_mask:0xf
    v_fmac_f32_dpp v70, v78, v18 quad_perm:[1,0,3,2] row_mask:0xf bank_mask:0xf
    v_fmac_f32_dpp v71, v79, v18 quad_perm:[1,0,3,2] row_mask:0xf bank_mask:0xf
    v_fmac_f32 v80, v17, v88
    v_fmac_f32 v81, v17, v89
    v_fmac_f32 v82, v17, v90
    v_fmac_f32 v83, v17, v91
    v_fmac_f32 v84, v17, v92
    v_fmac_f32 v85, v17, v93
    v_fmac_f32 v86, v17, v94
    v_fmac_f32 v87, v17, v95
    v_fmac_f32_dpp v80, v88, v18 quad_perm:[1,0,3,2] row_mask:0xf bank_mask:0xf
    v_fmac_f32_dpp v81, v89, v18 quad_perm:[1,0,3,2] row_mask:0xf bank_mask:0xf
    v_fmac_f32_dpp v82, v90, v18 quad_perm:[1,0,3,2] row_mask:0xf bank_mask:0xf
    v_fmac_f32_dpp v83, v91, v18 quad_perm:[1,0,3,2] row_mask:0xf bank_mask:0xf
    v_fmac_f32_dpp v84, v92, v18 quad_perm:[1,0,3,2] row_mask:0xf bank_mask:0xf
    v_fmac_f32_dpp v85, v93, v18 quad_perm:[1,0,3,2] row_mask:0xf bank_mask:0xf
    v_fmac_f32_dpp v86, v94, v18 quad_perm:[1,0,3,2] row_mask:0xf bank_mask:0xf
    v_fmac_f32_dpp v87, v95, v18 quad_perm:[1,0,3,2] row_mask:0xf bank_mask:0xf
    v_or_b32 v19, s5, v3
    v_cmp_eq_u32 vcc, 0, v19
    s_lshl_b32 s43, s5, 17
    s_lshl2_add_u32 s44, s10, s3
    s_lshr_b32 s45, s11, 1
    s_lshl1_add_u32 s44, s44, s45
    s_lshl_b32 s44, s44, 7
    s_add_u32 s43, s43, s44
    s_add_u32 s44, s43, 0x200000
    s_add_u32 s45, s43, 0x210000
    s_waitcnt lgkmcnt(0)
    v_cndmask_b32 v64, v64, v40, vcc
    v_cndmask_b32 v65, v65, v41, vcc
    v_cndmask_b32 v66, v66, v42, vcc
    v_cndmask_b32 v67, v67, v43, vcc
    v_cndmask_b32 v68, v68, v44, vcc
    v_cndmask_b32 v69, v69, v45, vcc
    v_cndmask_b32 v70, v70, v46, vcc
    v_cndmask_b32 v71, v71, v47, vcc
    v_mul_f32 v64, v64, v32
    v_mul_f32 v65, v65, v33
    v_mul_f32 v66, v66, v34
    v_mul_f32 v67, v67, v35
    v_mul_f32 v68, v68, v36
    v_mul_f32 v69, v69, v37
    v_mul_f32 v70, v70, v38
    v_mul_f32 v71, v71, v39
    v_cvt_pk_bf16_f32 v232, v64, v65
    v_cvt_pk_bf16_f32 v233, v66, v67
    v_cvt_pk_bf16_f32 v234, v68, v69
    v_cvt_pk_bf16_f32 v235, v70, v71
    buffer_store_dwordx4 v[232:235], v7, s[36:39], s44 offen sc1
    v_mul_f32 v80, v80, v32
    v_mul_f32 v81, v81, v33
    v_mul_f32 v82, v82, v34
    v_mul_f32 v83, v83, v35
    v_mul_f32 v84, v84, v36
    v_mul_f32 v85, v85, v37
    v_mul_f32 v86, v86, v38
    v_mul_f32 v87, v87, v39
    v_cvt_pk_bf16_f32 v236, v80, v81
    v_cvt_pk_bf16_f32 v237, v82, v83
    v_cvt_pk_bf16_f32 v238, v84, v85
    v_cvt_pk_bf16_f32 v239, v86, v87
    buffer_store_dwordx4 v[236:239], v7, s[36:39], s45 offen sc1
    s_setprio 0
    ds_read_b64_tr_b16 v[48:49], v13 offset:0
    ds_read_b64_tr_b16 v[50:51], v13 offset:512
    ds_read_b64_tr_b16 v[52:53], v13 offset:4096
    ds_read_b64_tr_b16 v[54:55], v13 offset:4608
    ds_read_b64_tr_b16 v[56:57], v13 offset:8192
    ds_read_b64_tr_b16 v[58:59], v13 offset:8704
    ds_read_b64_tr_b16 v[60:61], v13 offset:12288
    ds_read_b64_tr_b16 v[62:63], v13 offset:12800
    s_waitcnt lgkmcnt(6)
    v_mfma_f32_16x16x32_bf16 v[240:243], v[48:51], v[224:227], 0
    ds_read_b64_tr_b16 v[48:49], v13 offset:16384
    ds_read_b64_tr_b16 v[50:51], v13 offset:16896
    s_waitcnt lgkmcnt(6)
    v_mfma_f32_16x16x32_bf16 v[240:243], v[52:55], v[224:227], v[240:243]
    ds_read_b64_tr_b16 v[52:53], v13 offset:20480
    ds_read_b64_tr_b16 v[54:55], v13 offset:20992
    s_waitcnt lgkmcnt(6)
    v_mfma_f32_16x16x32_bf16 v[240:243], v[56:59], v[224:227], v[240:243]
    ds_read_b64_tr_b16 v[56:57], v13 offset:24576
    ds_read_b64_tr_b16 v[58:59], v13 offset:25088
    s_waitcnt lgkmcnt(6)
    v_mfma_f32_16x16x32_bf16 v[240:243], v[60:63], v[224:227], v[240:243]
    ds_read_b64_tr_b16 v[60:61], v13 offset:28672
    ds_read_b64_tr_b16 v[62:63], v13 offset:29184
    s_waitcnt lgkmcnt(6)
    v_mfma_f32_16x16x32_bf16 v[240:243], v[48:51], v[224:227], v[240:243]
    ds_read_b32 v19, v25 offset:0
    s_waitcnt lgkmcnt(0)
    v_readfirstlane_b32 s43, v19
    s_cmp_lt_u32 s43, 4
    s_cbranch_scc1 L_gs11
L_gx11:
    ds_read_b64_tr_b16 v[48:49], v13 offset:32768
    ds_read_b64_tr_b16 v[50:51], v13 offset:33280
    v_mfma_f32_16x16x32_bf16 v[240:243], v[52:55], v[224:227], v[240:243]
    ds_read_b64_tr_b16 v[52:53], v13 offset:36864
    ds_read_b64_tr_b16 v[54:55], v13 offset:37376
    v_mfma_f32_16x16x32_bf16 v[240:243], v[56:59], v[224:227], v[240:243]
    ds_read_b64_tr_b16 v[56:57], v13 offset:40960
    ds_read_b64_tr_b16 v[58:59], v13 offset:41472
    v_mfma_f32_16x16x32_bf16 v[240:243], v[60:63], v[224:227], v[240:243]
    ds_read_b64_tr_b16 v[60:61], v13 offset:45056
    ds_read_b64_tr_b16 v[62:63], v13 offset:45568
    s_waitcnt lgkmcnt(6)
    v_mfma_f32_16x16x32_bf16 v[240:243], v[48:51], v[224:227], v[240:243]
    ds_read_b64_tr_b16 v[48:49], v13 offset:49152
    ds_read_b64_tr_b16 v[50:51], v13 offset:49664
    s_waitcnt lgkmcnt(6)
    v_mfma_f32_16x16x32_bf16 v[240:243], v[52:55], v[224:227], v[240:243]
    ds_read_b64_tr_b16 v[52:53], v13 offset:53248
    ds_read_b64_tr_b16 v[54:55], v13 offset:53760
    s_waitcnt lgkmcnt(6)
    v_mfma_f32_16x16x32_bf16 v[240:243], v[56:59], v[224:227], v[240:243]
    ds_read_b64_tr_b16 v[56:57], v13 offset:57344
    ds_read_b64_tr_b16 v[58:59], v13 offset:57856
    s_waitcnt lgkmcnt(6)
    v_mfma_f32_16x16x32_bf16 v[240:243], v[60:63], v[224:227], v[240:243]
    ds_read_b64_tr_b16 v[60:61], v13 offset:61440
    ds_read_b64_tr_b16 v[62:63], v13 offset:61952
    s_waitcnt lgkmcnt(6)
    v_mfma_f32_16x16x32_bf16 v[240:243], v[48:51], v[224:227], v[240:243]
    s_waitcnt lgkmcnt(4)
    v_mfma_f32_16x16x32_bf16 v[240:243], v[52:55], v[224:227], v[240:243]
    s_waitcnt lgkmcnt(2)
    v_mfma_f32_16x16x32_bf16 v[240:243], v[56:59], v[224:227], v[240:243]
    s_waitcnt lgkmcnt(0)
    v_mfma_f32_16x16x32_bf16 v[240:243], v[60:63], v[224:227], v[240:243]
    s_nop 5
    s_mov_b32 exec_lo, 0x00010001
    s_mov_b32 exec_hi, 0x00010001
    ds_write_b128 v231, v[240:243] offset:0
    s_mov_b64 exec, -1
    v_mov_b32 v19, 1
    s_mov_b64 exec, 1
    ds_add_u32 v25, v19 offset:44
    s_mov_b64 exec, -1
    s_setprio 0
    s_setprio 0
    v_lshrrev_b32 v19, 2, v3
    v_lshl_add_u32 v19, v4, 2, v19
    v_bfe_u32 v30, v19, 1, 2
    v_lshlrev_b32 v19, 7, v19
    v_and_b32 v31, 1, v3
    v_lshl_add_u32 v19, v31, 3, v19
    v_lshlrev_b32 v30, 1, v30
    v_bfe_u32 v31, v3, 1, 1
    v_or_b32 v30, v30, v31
    v_lshl_add_u32 v124, v30, 4, v19
    v_lshrrev_b32 v19, 3, v1
    v_add_u32 v19, 8, v19
    v_and_b32 v30, 7, v1
    v_lshlrev_b32 v0, 15, v19
    v_lshl_add_u32 v0, v30, 4, v0
    v_lshlrev_b32 v30, 1, v30
    v_xor_b32 v30, v30, v19
    v_lshlrev_b32 v30, 4, v30
    v_lshl_add_u32 v30, v19, 8, v30
    s_lshl_b32 s43, s3, 12
    v_add_u32 v22, s43, v30
    v_xor_b32 v23, 16, v22
    v_xor_b32 v21, v4, v3
    v_lshlrev_b32 v21, 4, v21
    v_lshl_add_u32 v21, v3, 8, v21
    s_lshl_b32 s41, s11, 19
    s_lshl2_add_u32 s43, s10, s3
    s_lshl_b32 s43, s43, 10
    s_add_u32 s41, s41, s43
    s_lshl_b32 s43, s40, 7
    s_add_u32 s41, s41, s43
    v_add_u32 v6, 0x10000, v124
    s_xor_b32 s48, s2, 0x38
    v_min_u32 v19, 63, v1
    v_lshrrev_b32 v15, 2, v19
    v_lshlrev_b32 v15, 7, v15
    v_and_b32 v19, 3, v19
    v_lshl_add_u32 v15, v19, 2, v15
    v_and_b32 v14, 0x1ff, v15
    v_min_u32 v19, 1, v4
    v_mul_u32_u24 v19, 0x10000, v19
    v_add_u32 v14, v19, v14
    s_cmp_eq_u32 s48, 0
    s_cselect_b32 s43, 0x8000, 0
    v_lshrrev_b32 v19, 1, v4
    v_mul_u32_u24 v19, s43, v19
    v_add_u32 v14, v19, v14
    s_lshr_b32 s54, s48, 4
    s_lshl2_add_u32 s54, s54, s3
    s_lshl_b32 s54, s54, 9
    s_mov_b32 s55, 0
    v_add_u32 v26, 0x20000, v21
    v_xor_b32 v27, 64, v26
    v_xor_b32 v28, 128, v26
    v_xor_b32 v29, 192, v26
    s_lshr_b32 s43, s3, 1
    s_lshl_b32 s43, s43, 7
    s_and_b32 s44, s3, 1
    s_lshl3_add_u32 s43, s44, s43
    v_xor_b32 v10, s43, v26
    v_xor_b32 v11, 64, v10
    v_lshlrev_b32 v12, 5, v3
    v_lshl_add_u32 v12, v4, 3, v12
    s_lshl_b32 s43, s3, 10
    v_add_u32 v12, s43, v12
    s_lshl_b32 s51, s48, 13
    s_add_u32 s51, s51, 0x1000000
    s_add_u32 s52, s51, 4096
    s_mov_b32 s53, 0x36000000
    s_cmp_eq_u32 s48, 0
    s_cselect_b32 s52, 0x7f000000, s52
    s_cselect_b32 s53, 0x35800000, s53
    s_mov_b32 s50, 0
    s_lshl_b32 s43, s44, 3
    v_add_u32 v19, s43, v4
    v_xor_b32 v30, v19, v3
    v_lshlrev_b32 v30, 4, v30
    v_lshl_add_u32 v30, v4, 8, v30
    v_xor_b32 v24, 64, v30
    v_lshrrev_b32 v8, 3, v1
    v_and_b32 v9, 7, v1
    v_lshlrev_b32 v19, 1, v4
    v_xor_b32 v19, v19, v9
    v_lshlrev_b32 v19, 4, v19
    v_lshl_add_u32 v9, v8, 12, v19
    s_waitcnt vmcnt(0)
    s_mov_b64 exec, 1
    buffer_store_dword v5, off, s[36:39], s56 sc1
    s_mov_b64 exec, -1
    buffer_load_dwordx4 v[248:251], v0, s[12:15], s41 offen
    v_mul_f32 v192, s53, v192
    v_mul_f32 v193, s53, v193
    v_mul_f32 v194, s53, v194
    v_mul_f32 v195, s53, v195
    v_mul_f32 v196, s53, v196
    v_mul_f32 v197, s53, v197
    v_mul_f32 v198, s53, v198
    v_mul_f32 v199, s53, v199
    v_mul_f32 v200, s53, v200
    v_mul_f32 v201, s53, v201
    v_mul_f32 v202, s53, v202
    v_mul_f32 v203, s53, v203
    v_mul_f32 v204, s53, v204
    v_mul_f32 v205, s53, v205
    v_mul_f32 v206, s53, v206
    v_mul_f32 v207, s53, v207
    s_lshl_b32 s46, s40, 6
    s_lshl4_add_u32 s46, s3, s46
    v_add_u32 v32, s46, v3
    v_lshlrev_b32 v34, 1, v4
    v_cvt_f32_u32 v33, v32
    v_cvt_f32_u32 v34, v34
    v_mul_f32 v33, 0x3b000000, v33
    v_mul_f32 v31, 0x41800000, v33
    v_add_f32 v252, 0x00000000, v34
    v_add_f32 v253, 0x3f800000, v34
    v_add_f32 v254, 0x41000000, v34
    v_add_f32 v255, 0x41100000, v34
    v_fract_f32 v31, v31
    v_mul_f32 v252, v252, v33
    v_mul_f32 v253, v253, v33
    v_mul_f32 v254, v254, v33
    v_mul_f32 v255, v255, v33
    v_lshlrev_b32 v48, 31, v3
    v_min_u32 v49, 1, v4
    v_or_b32 v48, 0x3f800000, v48
    v_sub_u32 v49, v49, 1
    v_and_b32 v49, 0xffff0000, v49
    v_and_b32 v17, 1, v3
    v_mul_u32_u24 v17, 0x020202, v17
    v_lshl_or_b32 v17, v17, 8, v17
    v_xor_b32 v17, 0x03020100, v17
    v_bfe_u32 v18, v3, 1, 1
    v_add_u32 v50, 1, v3
    v_bfe_u32 v50, v50, 1, 1
    v_lshlrev_b32 v18, 15, v18
    v_lshl_or_b32 v18, v50, 31, v18
    v_cos_f32 v40, v252
    v_sin_f32_e64 v41, -v252
    v_cos_f32 v42, v253
    v_sin_f32_e64 v43, -v253
    v_cos_f32 v44, v254
    v_sin_f32_e64 v45, -v254
    v_cos_f32 v46, v255
    v_sin_f32_e64 v47, -v255
    v_add_f32 v252, v252, v31
    v_add_f32 v253, v253, v31
    v_add_f32 v254, v254, v31
    v_add_f32 v255, v255, v31
    v_cvt_pk_bf16_f32 v64, v40, v41
    v_cvt_pk_bf16_f32 v65, v42, v43
    v_cvt_pk_bf16_f32 v66, v44, v45
    v_cvt_pk_bf16_f32 v67, v46, v47
    v_perm_b32 v96, v64, v64, v17
    v_perm_b32 v97, v65, v65, v17
    v_perm_b32 v98, v66, v66, v17
    v_perm_b32 v99, v67, v67, v17
    v_xor_b32 v96, v18, v96
    v_xor_b32 v97, v18, v97
    v_xor_b32 v98, v18, v98
    v_xor_b32 v99, v18, v99
    v_bfi_b32 v64, v49, v48, v64
    ds_read_b32 v19, v25 offset:8
    s_waitcnt lgkmcnt(0)
    v_readfirstlane_b32 s43, v19
    s_cmp_lt_u32 s43, 4
    s_cbranch_scc1 L_gs12
L_gx12:
    ds_read_b32 v19, v25 offset:12
    s_waitcnt lgkmcnt(0)
    v_readfirstlane_b32 s43, v19
    s_cmp_lt_u32 s43, 4
    s_cbranch_scc1 L_gs13
L_gx13:
    s_setprio 0
    ds_read_b64_tr_b16 v[48:49], v20 offset:0
    ds_read_b64_tr_b16 v[50:51], v20 offset:512
    ds_read_b64_tr_b16 v[52:53], v20 offset:4096
    ds_read_b64_tr_b16 v[54:55], v20 offset:4608
    ds_read_b64_tr_b16 v[56:57], v20 offset:8192
    ds_read_b64_tr_b16 v[58:59], v20 offset:8704
    ds_read_b64_tr_b16 v[60:61], v20 offset:12288
    ds_read_b64_tr_b16 v[62:63], v20 offset:12800
    s_waitcnt lgkmcnt(6)
    v_mfma_f32_16x16x32_bf16 v[240:243], v[48:51], v[224:227], 0
    ds_read_b64_tr_b16 v[48:49], v20 offset:16384
    ds_read_b64_tr_b16 v[50:51], v20 offset:16896
    s_waitcnt lgkmcnt(6)
    v_mfma_f32_16x16x32_bf16 v[240:243], v[52:55], v[224:227], v[240:243]
    ds_read_b64_tr_b16 v[52:53], v20 offset:20480
    ds_read_b64_tr_b16 v[54:55], v20 offset:20992
    s_waitcnt lgkmcnt(6)
    v_mfma_f32_16x16x32_bf16 v[240:243], v[56:59], v[224:227], v[240:243]
    ds_read_b64_tr_b16 v[56:57], v20 offset:24576
    ds_read_b64_tr_b16 v[58:59], v20 offset:25088
    s_waitcnt lgkmcnt(6)
    v_mfma_f32_16x16x32_bf16 v[240:243], v[60:63], v[224:227], v[240:243]
    ds_read_b64_tr_b16 v[60:61], v20 offset:28672
    ds_read_b64_tr_b16 v[62:63], v20 offset:29184
    s_waitcnt lgkmcnt(6)
    v_mfma_f32_16x16x32_bf16 v[240:243], v[48:51], v[224:227], v[240:243]
    ds_read_b64_tr_b16 v[48:49], v20 offset:32768
    ds_read_b64_tr_b16 v[50:51], v20 offset:33280
    s_waitcnt lgkmcnt(6)
    v_mfma_f32_16x16x32_bf16 v[240:243], v[52:55], v[224:227], v[240:243]
    ds_read_b64_tr_b16 v[52:53], v20 offset:36864
    ds_read_b64_tr_b16 v[54:55], v20 offset:37376
    s_waitcnt lgkmcnt(6)
    v_mfma_f32_16x16x32_bf16 v[240:243], v[56:59], v[224:227], v[240:243]
    ds_read_b64_tr_b16 v[56:57], v20 offset:40960
    ds_read_b64_tr_b16 v[58:59], v20 offset:41472
    s_waitcnt lgkmcnt(6)
    v_mfma_f32_16x16x32_bf16 v[240:243], v[60:63], v[224:227], v[240:243]
    ds_read_b64_tr_b16 v[60:61], v20 offset:45056
    ds_read_b64_tr_b16 v[62:63], v20 offset:45568
    s_waitcnt lgkmcnt(6)
    v_mfma_f32_16x16x32_bf16 v[240:243], v[48:51], v[224:227], v[240:243]
    ds_read_b64_tr_b16 v[48:49], v20 offset:49152
    ds_read_b64_tr_b16 v[50:51], v20 offset:49664
    s_waitcnt lgkmcnt(6)
    v_mfma_f32_16x16x32_bf16 v[240:243], v[52:55], v[224:227], v[240:243]
    ds_read_b64_tr_b16 v[52:53], v20 offset:53248
    ds_read_b64_tr_b16 v[54:55], v20 offset:53760
    s_waitcnt lgkmcnt(6)
    v_mfma_f32_16x16x32_bf16 v[240:243], v[56:59], v[224:227], v[240:243]
    ds_read_b64_tr_b16 v[56:57], v20 offset:57344
    ds_read_b64_tr_b16 v[58:59], v20 offset:57856
    s_waitcnt lgkmcnt(6)
    v_mfma_f32_16x16x32_bf16 v[240:243], v[60:63], v[224:227], v[240:243]
    ds_read_b64_tr_b16 v[60:61], v20 offset:61440
    ds_read_b64_tr_b16 v[62:63], v20 offset:61952
    s_waitcnt lgkmcnt(6)
    v_mfma_f32_16x16x32_bf16 v[240:243], v[48:51], v[224:227], v[240:243]
    s_waitcnt lgkmcnt(4)
    v_mfma_f32_16x16x32_bf16 v[240:243], v[52:55], v[224:227], v[240:243]
    s_waitcnt lgkmcnt(2)
    v_mfma_f32_16x16x32_bf16 v[240:243], v[56:59], v[224:227], v[240:243]
    s_waitcnt lgkmcnt(0)
    v_mfma_f32_16x16x32_bf16 v[240:243], v[60:63], v[224:227], v[240:243]
    s_nop 5
    s_mov_b32 exec_lo, 0x00010001
    s_mov_b32 exec_hi, 0x00010001
    ds_write_b128 v231, v[240:243] offset:256
    s_mov_b64 exec, -1
    v_mov_b32 v19, 1
    s_mov_b64 exec, 1
    ds_add_u32 v25, v19 offset:48
    s_mov_b64 exec, -1
    s_setprio 0
    v_cos_f32 v40, v252
    v_sin_f32_e64 v41, -v252
    v_cos_f32 v42, v253
    v_sin_f32_e64 v43, -v253
    v_cos_f32 v44, v254
    v_sin_f32_e64 v45, -v254
    v_cos_f32 v46, v255
    v_sin_f32_e64 v47, -v255
    v_add_f32 v252, v252, v31
    v_add_f32 v253, v253, v31
    v_add_f32 v254, v254, v31
    v_add_f32 v255, v255, v31
    v_cvt_pk_bf16_f32 v68, v40, v41
    v_cvt_pk_bf16_f32 v69, v42, v43
    v_cvt_pk_bf16_f32 v70, v44, v45
    v_cvt_pk_bf16_f32 v71, v46, v47
    v_perm_b32 v100, v68, v68, v17
    v_perm_b32 v101, v69, v69, v17
    v_perm_b32 v102, v70, v70, v17
    v_perm_b32 v103, v71, v71, v17
    v_xor_b32 v100, v18, v100
    v_xor_b32 v101, v18, v101
    v_xor_b32 v102, v18, v102
    v_xor_b32 v103, v18, v103
    v_cos_f32 v40, v252
    v_sin_f32_e64 v41, -v252
    v_cos_f32 v42, v253
    v_sin_f32_e64 v43, -v253
    v_cos_f32 v44, v254
    v_sin_f32_e64 v45, -v254
    v_cos_f32 v46, v255
    v_sin_f32_e64 v47, -v255
    v_add_f32 v252, v252, v31
    v_add_f32 v253, v253, v31
    v_add_f32 v254, v254, v31
    v_add_f32 v255, v255, v31
    v_cvt_pk_bf16_f32 v72, v40, v41
    v_cvt_pk_bf16_f32 v73, v42, v43
    v_cvt_pk_bf16_f32 v74, v44, v45
    v_cvt_pk_bf16_f32 v75, v46, v47
    v_perm_b32 v104, v72, v72, v17
    v_perm_b32 v105, v73, v73, v17
    v_perm_b32 v106, v74, v74, v17
    v_perm_b32 v107, v75, v75, v17
    v_xor_b32 v104, v18, v104
    v_xor_b32 v105, v18, v105
    v_xor_b32 v106, v18, v106
    v_xor_b32 v107, v18, v107
    v_cos_f32 v40, v252
    v_sin_f32_e64 v41, -v252
    v_cos_f32 v42, v253
    v_sin_f32_e64 v43, -v253
    v_cos_f32 v44, v254
    v_sin_f32_e64 v45, -v254
    v_cos_f32 v46, v255
    v_sin_f32_e64 v47, -v255
    v_add_f32 v252, v252, v31
    v_add_f32 v253, v253, v31
    v_add_f32 v254, v254, v31
    v_add_f32 v255, v255, v31
    v_cvt_pk_bf16_f32 v76, v40, v41
    v_cvt_pk_bf16_f32 v77, v42, v43
    v_cvt_pk_bf16_f32 v78, v44, v45
    v_cvt_pk_bf16_f32 v79, v46, v47
    v_perm_b32 v108, v76, v76, v17
    v_perm_b32 v109, v77, v77, v17
    v_perm_b32 v110, v78, v78, v17
    v_perm_b32 v111, v79, v79, v17
    v_xor_b32 v108, v18, v108
    v_xor_b32 v109, v18, v109
    v_xor_b32 v110, v18, v110
    v_xor_b32 v111, v18, v111
    v_cos_f32 v40, v252
    v_sin_f32_e64 v41, -v252
    v_cos_f32 v42, v253
    v_sin_f32_e64 v43, -v253
    v_cos_f32 v44, v254
    v_sin_f32_e64 v45, -v254
    v_cos_f32 v46, v255
    v_sin_f32_e64 v47, -v255
    v_add_f32 v252, v252, v31
    v_add_f32 v253, v253, v31
    v_add_f32 v254, v254, v31
    v_add_f32 v255, v255, v31
    v_cvt_pk_bf16_f32 v80, v40, v41
    v_cvt_pk_bf16_f32 v81, v42, v43
    v_cvt_pk_bf16_f32 v82, v44, v45
    v_cvt_pk_bf16_f32 v83, v46, v47
    v_perm_b32 v112, v80, v80, v17
    v_perm_b32 v113, v81, v81, v17
    v_perm_b32 v114, v82, v82, v17
    v_perm_b32 v115, v83, v83, v17
    v_xor_b32 v112, v18, v112
    v_xor_b32 v113, v18, v113
    v_xor_b32 v114, v18, v114
    v_xor_b32 v115, v18, v115
    buffer_load_dword v13, v14, s[36:39], s54 offen sc1
    s_setprio 1
    s_waitcnt vmcnt(0)
    v_cmp_ne_u32 vcc, v13, v5
    s_cmp_lg_u64 vcc, 0
    s_cbranch_scc1 L_slow2
L_back2:
    s_lshl_b32 s43, s48, 13
    s_lshl_b32 s44, s3, 11
    s_add_u32 s43, s43, s44
    s_add_u32 s45, s43, 0x200000
    s_add_u32 m0, s44, 0x20000
    s_nop 0
    buffer_load_dwordx4 v30, s[36:39], s45 offen sc1 lds
    buffer_load_dwordx4 v24, s[36:39], s45 offen offset:1024 sc1 lds
    s_add_u32 s45, s43, 0x400000
    buffer_load_dwordx4 v[232:235], v2, s[36:39], s45 offen offset:0 sc1
    buffer_load_dwordx4 v[236:239], v2, s[36:39], s45 offen offset:1024 sc1
    s_add_u32 s45, s45, 0x200000
    s_cmp_eq_u32 s48, 0
    s_cselect_b32 s45, s45, 0x7f000000
    buffer_load_dwordx4 v[240:243], v2, s[36:39], s45 offen offset:0 sc1
    buffer_load_dwordx4 v[244:247], v2, s[36:39], s45 offen offset:1024 sc1
    s_waitcnt vmcnt(4)
    s_add_u32 s55, s55, 4
    v_mov_b32 v19, 1
    s_mov_b64 exec, 1
    ds_add_u32 v25, v19 offset:28
    s_mov_b64 exec, -1
    ds_read_b32 v19, v25 offset:28
    s_waitcnt lgkmcnt(0)
    v_readfirstlane_b32 s43, v19
    s_cmp_lt_u32 s43, s55
    s_cbranch_scc1 L_gs14
L_gx14:
L_ccol:
    ds_read_b128 v[32:35], v26 offset:0
    ds_read_b128 v[36:39], v28 offset:0
    ds_read_b128 v[40:43], v26 offset:4096
    ds_read_b128 v[44:47], v28 offset:4096
    ds_read_b128 v[48:51], v27 offset:0
    ds_read_b128 v[52:55], v29 offset:0
    ds_read_b128 v[56:59], v27 offset:4096
    ds_read_b128 v[60:63], v29 offset:4096
    s_waitcnt lgkmcnt(0)
    s_cmp_eq_u32 s48, 0
    s_cbranch_scc1 L_creal
L_cplx:
    v_mfma_f32_16x16x32_bf16 v[208:211], v[32:35], v[128:131], 0
    v_mfma_f32_16x16x32_bf16 v[216:219], v[48:51], v[128:131], 0
    v_mfma_f32_16x16x32_bf16 v[208:211], v[48:51], v[136:139], v[208:211]
    v_mfma_f32_16x16x32_bf16 v[216:219], v[32:35], v[144:147], v[216:219]
    v_mfma_f32_16x16x32_bf16 v[208:211], v[36:39], v[132:135], v[208:211]
    v_mfma_f32_16x16x32_bf16 v[216:219], v[52:55], v[132:135], v[216:219]
    v_mfma_f32_16x16x32_bf16 v[208:211], v[52:55], v[140:143], v[208:211]
    v_mfma_f32_16x16x32_bf16 v[216:219], v[36:39], v[148:151], v[216:219]
    v_mfma_f32_16x16x32_bf16 v[212:215], v[40:43], v[128:131], 0
    v_mfma_f32_16x16x32_bf16 v[220:223], v[56:59], v[128:131], 0
    v_mfma_f32_16x16x32_bf16 v[212:215], v[56:59], v[136:139], v[212:215]
    v_mfma_f32_16x16x32_bf16 v[220:223], v[40:43], v[144:147], v[220:223]
    v_mfma_f32_16x16x32_bf16 v[212:215], v[44:47], v[132:135], v[212:215]
    v_mfma_f32_16x16x32_bf16 v[220:223], v[60:63], v[132:135], v[220:223]
    v_mfma_f32_16x16x32_bf16 v[212:215], v[60:63], v[140:143], v[212:215]
    v_mfma_f32_16x16x32_bf16 v[220:223], v[44:47], v[148:151], v[220:223]
    v_pk_mul_f32 v[32:33], v[208:209], v[176:177]
    v_pk_mul_f32 v[40:41], v[216:217], v[176:177]
    v_pk_mul_f32 v[34:35], v[210:211], v[178:179]
    v_pk_mul_f32 v[42:43], v[218:219], v[178:179]
    v_pk_fma_f32 v[32:33], v[216:217], v[184:185], v[32:33]
    v_pk_fma_f32 v[40:41], v[208:209], v[184:185], v[40:41] neg_lo:[1,0,0] neg_hi:[1,0,0]
    v_pk_fma_f32 v[34:35], v[218:219], v[186:187], v[34:35]
    v_pk_fma_f32 v[42:43], v[210:211], v[186:187], v[42:43] neg_lo:[1,0,0] neg_hi:[1,0,0]
    v_pk_mul_f32 v[36:37], v[212:213], v[180:181]
    v_pk_mul_f32 v[44:45], v[220:221], v[180:181]
    v_pk_mul_f32 v[38:39], v[214:215], v[182:183]
    v_pk_mul_f32 v[46:47], v[222:223], v[182:183]
    v_pk_fma_f32 v[36:37], v[220:221], v[188:189], v[36:37]
    v_pk_fma_f32 v[44:45], v[212:213], v[188:189], v[44:45] neg_lo:[1,0,0] neg_hi:[1,0,0]
    v_pk_fma_f32 v[38:39], v[222:223], v[190:191], v[38:39]
    v_pk_fma_f32 v[46:47], v[214:215], v[190:191], v[46:47] neg_lo:[1,0,0] neg_hi:[1,0,0]
    v_cvt_pk_bf16_f32 v224, v32, v33
    v_cvt_pk_bf16_f32 v228, v40, v41
    v_cvt_pk_bf16_f32 v225, v34, v35
    v_cvt_pk_bf16_f32 v229, v42, v43
    v_cvt_pk_bf16_f32 v226, v36, v37
    v_cvt_pk_bf16_f32 v230, v44, v45
    v_cvt_pk_bf16_f32 v227, v38, v39
    v_cvt_pk_bf16_f32 v231, v46, v47
    s_nop 1
    v_mfma_f32_16x16x32_bf16 v[208:211], v[152:155], v[224:227], 0
    v_mfma_f32_16x16x32_bf16 v[216:219], v[152:155], v[228:231], 0
    v_mfma_f32_16x16x32_bf16 v[208:211], v[160:163], v[228:231], v[208:211]
    v_mfma_f32_16x16x32_bf16 v[216:219], v[168:171], v[224:227], v[216:219]
    v_mfma_f32_16x16x32_bf16 v[212:215], v[156:159], v[224:227], 0
    v_mfma_f32_16x16x32_bf16 v[220:223], v[156:159], v[228:231], 0
    v_mfma_f32_16x16x32_bf16 v[212:215], v[164:167], v[228:231], v[212:215]
    v_mfma_f32_16x16x32_bf16 v[220:223], v[172:175], v[224:227], v[220:223]
    s_waitcnt vmcnt(0)
    v_lshlrev_b32 v48, 16, v232
    v_and_b32 v56, 0xffff0000, v232
    v_lshlrev_b32 v49, 16, v233
    v_and_b32 v57, 0xffff0000, v233
    v_lshlrev_b32 v50, 16, v234
    v_and_b32 v58, 0xffff0000, v234
    v_lshlrev_b32 v51, 16, v235
    v_and_b32 v59, 0xffff0000, v235
    v_lshlrev_b32 v52, 16, v236
    v_and_b32 v60, 0xffff0000, v236
    v_lshlrev_b32 v53, 16, v237
    v_and_b32 v61, 0xffff0000, v237
    v_lshlrev_b32 v54, 16, v238
    v_and_b32 v62, 0xffff0000, v238
    v_lshlrev_b32 v55, 16, v239
    v_and_b32 v63, 0xffff0000, v239
    v_pk_mul_f32 v[32:33], v[208:209], v[48:49]
    v_pk_mul_f32 v[40:41], v[216:217], v[48:49]
    v_pk_mul_f32 v[34:35], v[210:211], v[50:51]
    v_pk_mul_f32 v[42:43], v[218:219], v[50:51]
    v_pk_fma_f32 v[32:33], v[216:217], v[56:57], v[32:33] neg_lo:[1,0,0] neg_hi:[1,0,0]
    v_pk_fma_f32 v[40:41], v[208:209], v[56:57], v[40:41]
    v_pk_fma_f32 v[34:35], v[218:219], v[58:59], v[34:35] neg_lo:[1,0,0] neg_hi:[1,0,0]
    v_pk_fma_f32 v[42:43], v[210:211], v[58:59], v[42:43]
    v_pk_mul_f32 v[36:37], v[212:213], v[52:53]
    v_pk_mul_f32 v[44:45], v[220:221], v[52:53]
    v_pk_mul_f32 v[38:39], v[214:215], v[54:55]
    v_pk_mul_f32 v[46:47], v[222:223], v[54:55]
    v_pk_fma_f32 v[36:37], v[220:221], v[60:61], v[36:37] neg_lo:[1,0,0] neg_hi:[1,0,0]
    v_pk_fma_f32 v[44:45], v[212:213], v[60:61], v[44:45]
    v_pk_fma_f32 v[38:39], v[222:223], v[62:63], v[38:39] neg_lo:[1,0,0] neg_hi:[1,0,0]
    v_pk_fma_f32 v[46:47], v[214:215], v[62:63], v[46:47]
    v_cvt_pk_bf16_f32 v224, v32, v33
    v_cvt_pk_bf16_f32 v228, v40, v41
    v_cvt_pk_bf16_f32 v225, v34, v35
    v_cvt_pk_bf16_f32 v229, v42, v43
    v_cvt_pk_bf16_f32 v226, v36, v37
    v_cvt_pk_bf16_f32 v230, v44, v45
    v_cvt_pk_bf16_f32 v227, v38, v39
    v_cvt_pk_bf16_f32 v231, v46, v47
    s_nop 1
    v_mfma_f32_16x16x32_bf16 v[208:211], v[224:227], v[152:155], 0
    v_mfma_f32_16x16x32_bf16 v[216:219], v[228:231], v[152:155], 0
    v_mfma_f32_16x16x32_bf16 v[208:211], v[228:231], v[168:171], v[208:211]
    v_mfma_f32_16x16x32_bf16 v[216:219], v[224:227], v[160:163], v[216:219]
    v_mfma_f32_16x16x32_bf16 v[212:215], v[224:227], v[156:159], 0
    v_mfma_f32_16x16x32_bf16 v[220:223], v[228:231], v[156:159], 0
    v_mfma_f32_16x16x32_bf16 v[212:215], v[228:231], v[172:175], v[212:215]
    v_mfma_f32_16x16x32_bf16 v[220:223], v[224:227], v[164:167], v[220:223]
    s_nop 3
    v_pk_mul_f32 v[32:33], v[208:209], v[192:193]
    v_pk_mul_f32 v[40:41], v[216:217], v[192:193]
    v_pk_mul_f32 v[34:35], v[210:211], v[194:195]
    v_pk_mul_f32 v[42:43], v[218:219], v[194:195]
    v_pk_fma_f32 v[32:33], v[216:217], v[200:201], v[32:33] neg_lo:[1,0,0] neg_hi:[1,0,0]
    v_pk_fma_f32 v[40:41], v[208:209], v[200:201], v[40:41]
    v_pk_fma_f32 v[34:35], v[218:219], v[202:203], v[34:35] neg_lo:[1,0,0] neg_hi:[1,0,0]
    v_pk_fma_f32 v[42:43], v[210:211], v[202:203], v[42:43]
    v_pk_mul_f32 v[36:37], v[212:213], v[196:197]
    v_pk_mul_f32 v[44:45], v[220:221], v[196:197]
    v_pk_mul_f32 v[38:39], v[214:215], v[198:199]
    v_pk_mul_f32 v[46:47], v[222:223], v[198:199]
    v_pk_fma_f32 v[36:37], v[220:221], v[204:205], v[36:37] neg_lo:[1,0,0] neg_hi:[1,0,0]
    v_pk_fma_f32 v[44:45], v[212:213], v[204:205], v[44:45]
    v_pk_fma_f32 v[38:39], v[222:223], v[206:207], v[38:39] neg_lo:[1,0,0] neg_hi:[1,0,0]
    v_pk_fma_f32 v[46:47], v[214:215], v[206:207], v[46:47]
    v_cvt_pk_bf16_f32 v224, v32, v33
    v_cvt_pk_bf16_f32 v228, v40, v41
    v_cvt_pk_bf16_f32 v225, v34, v35
    v_cvt_pk_bf16_f32 v229, v42, v43
    v_cvt_pk_bf16_f32 v226, v36, v37
    v_cvt_pk_bf16_f32 v230, v44, v45
    v_cvt_pk_bf16_f32 v227, v38, v39
    v_cvt_pk_bf16_f32 v231, v46, v47
    s_nop 1
    ds_write_b64 v10, v[224:225] offset:8192
    ds_write_b64 v11, v[228:229] offset:8192
    ds_write_b64 v10, v[226:227] offset:12288
    ds_write_b64 v11, v[230:231] offset:12288
    s_waitcnt lgkmcnt(0)
    s_add_u32 s55, s55, 4
    v_mov_b32 v19, 1
    s_mov_b64 exec, 1
    ds_add_u32 v25, v19 offset:28
    s_mov_b64 exec, -1
    ds_read_b32 v19, v25 offset:28
    s_waitcnt lgkmcnt(0)
    v_readfirstlane_b32 s43, v19
    s_cmp_lt_u32 s43, s55
    s_cbranch_scc1 L_gs15
L_gx15:
    ds_read_b128 v[32:35], v26 offset:8192
    ds_read_b128 v[48:51], v27 offset:8192
    ds_read_b128 v[36:39], v28 offset:8192
    ds_read_b128 v[52:55], v29 offset:8192
    ds_read_b128 v[40:43], v26 offset:12288
    ds_read_b128 v[56:59], v27 offset:12288
    ds_read_b128 v[44:47], v28 offset:12288
    ds_read_b128 v[60:63], v29 offset:12288
    s_waitcnt lgkmcnt(6)
    v_mfma_f32_16x16x32_bf16 v[208:211], v[128:131], v[32:35], 0
    v_mfma_f32_16x16x32_bf16 v[216:219], v[128:131], v[48:51], 0
    v_mfma_f32_16x16x32_bf16 v[208:211], v[144:147], v[48:51], v[208:211]
    v_mfma_f32_16x16x32_bf16 v[216:219], v[136:139], v[32:35], v[216:219]
    s_waitcnt lgkmcnt(4)
    v_mfma_f32_16x16x32_bf16 v[208:211], v[132:135], v[36:39], v[208:211]
    v_mfma_f32_16x16x32_bf16 v[216:219], v[132:135], v[52:55], v[216:219]
    v_mfma_f32_16x16x32_bf16 v[208:211], v[148:151], v[52:55], v[208:211]
    v_mfma_f32_16x16x32_bf16 v[216:219], v[140:143], v[36:39], v[216:219]
    s_waitcnt lgkmcnt(2)
    v_mfma_f32_16x16x32_bf16 v[212:215], v[128:131], v[40:43], 0
    v_mfma_f32_16x16x32_bf16 v[220:223], v[128:131], v[56:59], 0
    v_mfma_f32_16x16x32_bf16 v[212:215], v[144:147], v[56:59], v[212:215]
    v_mfma_f32_16x16x32_bf16 v[220:223], v[136:139], v[40:43], v[220:223]
    s_waitcnt lgkmcnt(0)
    v_mfma_f32_16x16x32_bf16 v[212:215], v[132:135], v[44:47], v[212:215]
    v_mfma_f32_16x16x32_bf16 v[220:223], v[132:135], v[60:63], v[220:223]
    v_mfma_f32_16x16x32_bf16 v[212:215], v[148:151], v[60:63], v[212:215]
    v_mfma_f32_16x16x32_bf16 v[220:223], v[140:143], v[44:47], v[220:223]
    v_cvt_pk_bf16_f32 v224, v208, v209
    v_cvt_pk_bf16_f32 v228, v216, v217
    v_cvt_pk_bf16_f32 v225, v210, v211
    v_cvt_pk_bf16_f32 v229, v218, v219
    buffer_store_dwordx2 v[224:225], v12, s[36:39], s51 offen offset:0 sc1
    buffer_store_dwordx2 v[228:229], v12, s[36:39], s52 offen offset:0 sc1
    s_nop 3
    v_cvt_pk_bf16_f32 v226, v212, v213
    v_cvt_pk_bf16_f32 v230, v220, v221
    v_cvt_pk_bf16_f32 v227, v214, v215
    v_cvt_pk_bf16_f32 v231, v222, v223
    buffer_store_dwordx2 v[226:227], v12, s[36:39], s51 offen offset:512 sc1
    buffer_store_dwordx2 v[230:231], v12, s[36:39], s52 offen offset:512 sc1
    s_or_b32 s43, s48, s50
    s_cbranch_scc0 L_csecond
    s_lshr_b32 s47, s48, 2
    s_lshl_b32 s44, s3, 6
    s_add_u32 s47, s47, s44
    s_lshl_b32 s47, s47, 7
    s_and_b32 s44, s48, 3
    s_lshl2_add_u32 s47, s44, s47
    s_add_u32 s47, s47, 0x30000
    s_lshl3_add_u32 s54, s11, s3
    s_lshl_b32 s54, s54, 10
    s_add_u32 s54, s54, 0x31000
    v_and_b32 v15, 0x3ff, v15
    s_lshl_b32 s51, s3, 18
    s_lshl_b32 s44, s11, 10
    s_add_u32 s51, s51, s44
    s_lshl_b32 s44, s10, 7
    s_add_u32 s51, s51, s44
    s_lshl_b32 s52, s3, 13
    s_lshl_b32 s44, s3, 6
    v_xor_b32 v20, s44, v26
    s_waitcnt vmcnt(0)
    s_mov_b64 exec, 1
    buffer_store_dword v5, off, s[36:39], s47 sc1
    s_mov_b64 exec, -1
    s_setprio 0
    v_cos_f32 v40, v252
    v_sin_f32_e64 v41, -v252
    v_cos_f32 v42, v253
    v_sin_f32_e64 v43, -v253
    v_cos_f32 v44, v254
    v_sin_f32_e64 v45, -v254
    v_cos_f32 v46, v255
    v_sin_f32_e64 v47, -v255
    v_add_f32 v252, v252, v31
    v_add_f32 v253, v253, v31
    v_add_f32 v254, v254, v31
    v_add_f32 v255, v255, v31
    v_cvt_pk_bf16_f32 v84, v40, v41
    v_cvt_pk_bf16_f32 v85, v42, v43
    v_cvt_pk_bf16_f32 v86, v44, v45
    v_cvt_pk_bf16_f32 v87, v46, v47
    v_perm_b32 v116, v84, v84, v17
    v_perm_b32 v117, v85, v85, v17
    v_perm_b32 v118, v86, v86, v17
    v_perm_b32 v119, v87, v87, v17
    v_xor_b32 v116, v18, v116
    v_xor_b32 v117, v18, v117
    v_xor_b32 v118, v18, v118
    v_xor_b32 v119, v18, v119
    v_cos_f32 v40, v252
    v_sin_f32_e64 v41, -v252
    v_cos_f32 v42, v253
    v_sin_f32_e64 v43, -v253
    v_cos_f32 v44, v254
    v_sin_f32_e64 v45, -v254
    v_cos_f32 v46, v255
    v_sin_f32_e64 v47, -v255
    v_add_f32 v252, v252, v31
    v_add_f32 v253, v253, v31
    v_add_f32 v254, v254, v31
    v_add_f32 v255, v255, v31
    v_cvt_pk_bf16_f32 v88, v40, v41
    v_cvt_pk_bf16_f32 v89, v42, v43
    v_cvt_pk_bf16_f32 v90, v44, v45
    v_cvt_pk_bf16_f32 v91, v46, v47
    v_perm_b32 v120, v88, v88, v17
    v_perm_b32 v121, v89, v89, v17
    v_perm_b32 v122, v90, v90, v17
    v_perm_b32 v123, v91, v91, v17
    v_xor_b32 v120, v18, v120
    v_xor_b32 v121, v18, v121
    v_xor_b32 v122, v18, v122
    v_xor_b32 v123, v18, v123
    v_cos_f32 v40, v252
    v_sin_f32_e64 v41, -v252
    v_cos_f32 v42, v253
    v_sin_f32_e64 v43, -v253
    v_cos_f32 v44, v254
    v_sin_f32_e64 v45, -v254
    v_cos_f32 v46, v255
    v_sin_f32_e64 v47, -v255
    v_add_f32 v252, v252, v31
    v_add_f32 v253, v253, v31
    v_add_f32 v254, v254, v31
    v_add_f32 v255, v255, v31
    v_cvt_pk_bf16_f32 v92, v40, v41
    v_cvt_pk_bf16_f32 v93, v42, v43
    v_cvt_pk_bf16_f32 v94, v44, v45
    v_cvt_pk_bf16_f32 v95, v46, v47
    v_perm_b32 v124, v92, v92, v17
    v_perm_b32 v125, v93, v93, v17
    v_perm_b32 v126, v94, v94, v17
    v_perm_b32 v127, v95, v95, v17
    v_xor_b32 v124, v18, v124
    v_xor_b32 v125, v18, v125
    v_xor_b32 v126, v18, v126
    v_xor_b32 v127, v18, v127
    v_add_u32 v19, 0xe000, v6
    v_xor_b32 v16, 0, v6
    v_xor_b32 v26, 0, v19
    v_xor_b32 v17, 32, v6
    v_xor_b32 v27, 32, v19
    v_xor_b32 v18, 64, v6
    v_xor_b32 v28, 64, v19
    v_xor_b32 v7, 96, v6
    v_xor_b32 v29, 96, v19
    s_add_u32 s55, s55, 4
    v_mov_b32 v19, 1
    s_mov_b64 exec, 1
    ds_add_u32 v25, v19 offset:28
    s_mov_b64 exec, -1
    ds_read_b32 v19, v25 offset:28
    s_waitcnt lgkmcnt(0)
    v_readfirstlane_b32 s43, v19
    s_cmp_lt_u32 s43, s55
    s_cbranch_scc1 L_gs17
L_gx17:
    s_setprio 1
    ds_read_b32 v19, v25 offset:20
    s_waitcnt lgkmcnt(0)
    v_readfirstlane_b32 s43, v19
    s_cmp_lt_u32 s43, 4
    s_cbranch_scc1 L_gs18
L_gx18:
    buffer_load_dword v30, v15, s[36:39], s54 offen sc1
    s_add_u32 s1, s51, 0x10f8000
    s_waitcnt vmcnt(0)
    v_cmp_ne_u32 vcc, v30, v5
    s_cmp_lg_u64 vcc, 0
    s_cbranch_scc1 L_slow3
L_back3:
    s_add_u32 m0, s52, 122880
    s_add_u32 s1, s1, 32768
    buffer_load_dwordx4 v9, s[36:39], s1 offen sc1 lds
    s_add_u32 m0, s52, 123904
    s_add_u32 s1, s1, 32768
    buffer_load_dwordx4 v9, s[36:39], s1 offen sc1 lds
    s_add_u32 m0, s52, 124928
    s_add_u32 s1, s1, 32768
    buffer_load_dwordx4 v9, s[36:39], s1 offen sc1 lds
    s_add_u32 m0, s52, 125952
    s_add_u32 s1, s1, 32768
    buffer_load_dwordx4 v9, s[36:39], s1 offen sc1 lds
    s_add_u32 m0, s52, 126976
    s_add_u32 s1, s1, 32768
    buffer_load_dwordx4 v9, s[36:39], s1 offen sc1 lds
    s_add_u32 m0, s52, 128000
    s_add_u32 s1, s1, 32768
    buffer_load_dwordx4 v9, s[36:39], s1 offen sc1 lds
    s_add_u32 m0, s52, 129024
    s_add_u32 s1, s1, 32768
    buffer_load_dwordx4 v9, s[36:39], s1 offen sc1 lds
    s_add_u32 m0, s52, 130048
    s_add_u32 s1, s1, 32768
    buffer_load_dwordx4 v9, s[36:39], s1 offen sc1 lds
    s_setprio 0
    s_sub_u32 s54, s54, 4096
    s_setprio 1
    ds_read_b32 v19, v25 offset:24
    s_waitcnt lgkmcnt(0)
    v_readfirstlane_b32 s43, v19
    s_cmp_lt_u32 s43, 4
    s_cbranch_scc1 L_gs19
L_gx19:
    buffer_load_dword v30, v15, s[36:39], s54 offen sc1
    s_add_u32 s1, s51, 0xff8000
    s_waitcnt vmcnt(0)
    v_cmp_ne_u32 vcc, v30, v5
    s_cmp_lg_u64 vcc, 0
    s_cbranch_scc1 L_slow4
L_back4:
    s_add_u32 m0, s52, 65536
    s_add_u32 s1, s1, 32768
    buffer_load_dwordx4 v9, s[36:39], s1 offen sc1 lds
    s_add_u32 m0, s52, 66560
    s_add_u32 s1, s1, 32768
    buffer_load_dwordx4 v9, s[36:39], s1 offen sc1 lds
    s_add_u32 m0, s52, 67584
    s_add_u32 s1, s1, 32768
    buffer_load_dwordx4 v9, s[36:39], s1 offen sc1 lds
    s_add_u32 m0, s52, 68608
    s_add_u32 s1, s1, 32768
    buffer_load_dwordx4 v9, s[36:39], s1 offen sc1 lds
    s_add_u32 m0, s52, 69632
    s_add_u32 s1, s1, 32768
    buffer_load_dwordx4 v9, s[36:39], s1 offen sc1 lds
    s_add_u32 m0, s52, 70656
    s_add_u32 s1, s1, 32768
    buffer_load_dwordx4 v9, s[36:39], s1 offen sc1 lds
    s_add_u32 m0, s52, 71680
    s_add_u32 s1, s1, 32768
    buffer_load_dwordx4 v9, s[36:39], s1 offen sc1 lds
    s_add_u32 m0, s52, 72704
    s_add_u32 s1, s1, 32768
    buffer_load_dwordx4 v9, s[36:39], s1 offen sc1 lds
    s_setprio 0
    s_add_u32 s55, s55, 4
    v_mov_b32 v19, 1
    s_mov_b64 exec, 1
    ds_add_u32 v25, v19 offset:28
    s_mov_b64 exec, -1
    ds_read_b32 v19, v25 offset:28
    s_waitcnt lgkmcnt(0)
    v_readfirstlane_b32 s43, v19
    s_cmp_lt_u32 s43, s55
    s_cbranch_scc1 L_gs20
L_gx20:
    ds_read_b64_tr_b16 v[128:129], v26 offset:0
    ds_read_b64_tr_b16 v[130:131], v26 offset:2048
    ds_read_b64_tr_b16 v[132:133], v27 offset:0
    ds_read_b64_tr_b16 v[134:135], v27 offset:2048
    ds_read_b64_tr_b16 v[136:137], v28 offset:0
    ds_read_b64_tr_b16 v[138:139], v28 offset:2048
    ds_read_b64_tr_b16 v[140:141], v29 offset:0
    ds_read_b64_tr_b16 v[142:143], v29 offset:2048
    ds_read_b64_tr_b16 v[144:145], v26 offset:4096
    ds_read_b64_tr_b16 v[146:147], v26 offset:6144
    ds_read_b64_tr_b16 v[148:149], v27 offset:4096
    ds_read_b64_tr_b16 v[150:151], v27 offset:6144
    ds_read_b64_tr_b16 v[152:153], v28 offset:4096
    ds_read_b64_tr_b16 v[154:155], v28 offset:6144
    s_waitcnt lgkmcnt(12)
    v_mfma_f32_16x16x32_bf16 v[208:211], v[96:99], v[128:131], 0
    ds_read_b64_tr_b16 v[156:157], v29 offset:4096
    ds_read_b64_tr_b16 v[158:159], v29 offset:6144
    s_waitcnt lgkmcnt(12)
    v_mfma_f32_16x16x32_bf16 v[212:215], v[96:99], v[132:135], 0
    ds_read_b64_tr_b16 v[160:161], v26 offset:8192
    ds_read_b64_tr_b16 v[162:163], v26 offset:10240
    s_waitcnt lgkmcnt(12)
    v_mfma_f32_16x16x32_bf16 v[216:219], v[96:99], v[136:139], 0
    ds_read_b64_tr_b16 v[164:165], v27 offset:8192
    ds_read_b64_tr_b16 v[166:167], v27 offset:10240
    s_waitcnt lgkmcnt(12)
    v_mfma_f32_16x16x32_bf16 v[220:223], v[96:99], v[140:143], 0
    ds_read_b64_tr_b16 v[168:169], v28 offset:8192
    ds_read_b64_tr_b16 v[170:171], v28 offset:10240
    s_waitcnt lgkmcnt(12)
    v_mfma_f32_16x16x32_bf16 v[208:211], v[100:103], v[144:147], v[208:211]
    ds_read_b64_tr_b16 v[172:173], v29 offset:8192
    ds_read_b64_tr_b16 v[174:175], v29 offset:10240
    s_waitcnt lgkmcnt(12)
    v_mfma_f32_16x16x32_bf16 v[212:215], v[100:103], v[148:151], v[212:215]
    ds_read_b64_tr_b16 v[176:177], v26 offset:12288
    ds_read_b64_tr_b16 v[178:179], v26 offset:14336
    s_waitcnt lgkmcnt(12)
    v_mfma_f32_16x16x32_bf16 v[216:219], v[100:103], v[152:155], v[216:219]
    ds_read_b64_tr_b16 v[180:181], v27 offset:12288
    ds_read_b64_tr_b16 v[182:183], v27 offset:14336
    s_waitcnt lgkmcnt(12)
    v_mfma_f32_16x16x32_bf16 v[220:223], v[100:103], v[156:159], v[220:223]
    ds_read_b64_tr_b16 v[184:185], v28 offset:12288
    ds_read_b64_tr_b16 v[186:187], v28 offset:14336
    s_waitcnt lgkmcnt(12)
    v_mfma_f32_16x16x32_bf16 v[208:211], v[104:107], v[160:163], v[208:211]
    ds_read_b64_tr_b16 v[188:189], v29 offset:12288
    ds_read_b64_tr_b16 v[190:191], v29 offset:14336
    s_waitcnt lgkmcnt(12)
    v_mfma_f32_16x16x32_bf16 v[212:215], v[104:107], v[164:167], v[212:215]
    ds_read_b64_tr_b16 v[128:129], v26 offset:16384
    ds_read_b64_tr_b16 v[130:131], v26 offset:18432
    s_waitcnt lgkmcnt(12)
    v_mfma_f32_16x16x32_bf16 v[216:219], v[104:107], v[168:171], v[216:219]
    ds_read_b64_tr_b16 v[132:133], v27 offset:16384
    ds_read_b64_tr_b16 v[134:135], v27 offset:18432
    s_waitcnt lgkmcnt(12)
    v_mfma_f32_16x16x32_bf16 v[220:223], v[104:107], v[172:175], v[220:223]
    ds_read_b64_tr_b16 v[136:137], v28 offset:16384
    ds_read_b64_tr_b16 v[138:139], v28 offset:18432
    s_waitcnt lgkmcnt(12)
    v_mfma_f32_16x16x32_bf16 v[208:211], v[108:111], v[176:179], v[208:211]
    ds_read_b64_tr_b16 v[140:141], v29 offset:16384
    ds_read_b64_tr_b16 v[142:143], v29 offset:18432
    s_waitcnt lgkmcnt(12)
    v_mfma_f32_16x16x32_bf16 v[212:215], v[108:111], v[180:183], v[212:215]
    ds_read_b64_tr_b16 v[144:145], v26 offset:20480
    ds_read_b64_tr_b16 v[146:147], v26 offset:22528
    s_waitcnt lgkmcnt(12)
    v_mfma_f32_16x16x32_bf16 v[216:219], v[108:111], v[184:187], v[216:219]
    ds_read_b64_tr_b16 v[148:149], v27 offset:20480
    ds_read_b64_tr_b16 v[150:151], v27 offset:22528
    s_waitcnt lgkmcnt(12)
    v_mfma_f32_16x16x32_bf16 v[220:223], v[108:111], v[188:191], v[220:223]
    ds_read_b64_tr_b16 v[152:153], v28 offset:20480
    ds_read_b64_tr_b16 v[154:155], v28 offset:22528
    s_waitcnt lgkmcnt(12)
    v_mfma_f32_16x16x32_bf16 v[208:211], v[112:115], v[128:131], v[208:211]
    ds_read_b64_tr_b16 v[156:157], v29 offset:20480
    ds_read_b64_tr_b16 v[158:159], v29 offset:22528
    s_waitcnt lgkmcnt(12)
    v_mfma_f32_16x16x32_bf16 v[212:215], v[112:115], v[132:135], v[212:215]
    ds_read_b64_tr_b16 v[160:161], v26 offset:24576
    ds_read_b64_tr_b16 v[162:163], v26 offset:26624
    s_waitcnt lgkmcnt(12)
    v_mfma_f32_16x16x32_bf16 v[216:219], v[112:115], v[136:139], v[216:219]
    ds_read_b64_tr_b16 v[164:165], v27 offset:24576
    ds_read_b64_tr_b16 v[166:167], v27 offset:26624
    s_waitcnt lgkmcnt(12)
    v_mfma_f32_16x16x32_bf16 v[220:223], v[112:115], v[140:143], v[220:223]
    ds_read_b64_tr_b16 v[168:169], v28 offset:24576
    ds_read_b64_tr_b16 v[170:171], v28 offset:26624
    s_waitcnt lgkmcnt(12)
    v_mfma_f32_16x16x32_bf16 v[208:211], v[116:119], v[144:147], v[208:211]
    ds_read_b64_tr_b16 v[172:173], v29 offset:24576
    ds_read_b64_tr_b16 v[174:175], v29 offset:26624
    s_waitcnt lgkmcnt(12)
    v_mfma_f32_16x16x32_bf16 v[212:215], v[116:119], v[148:151], v[212:215]
    ds_read_b64_tr_b16 v[176:177], v26 offset:28672
    ds_read_b64_tr_b16 v[178:179], v26 offset:30720
    s_waitcnt lgkmcnt(12)
    v_mfma_f32_16x16x32_bf16 v[216:219], v[116:119], v[152:155], v[216:219]
    ds_read_b64_tr_b16 v[180:181], v27 offset:28672
    ds_read_b64_tr_b16 v[182:183], v27 offset:30720
    s_waitcnt lgkmcnt(12)
    v_mfma_f32_16x16x32_bf16 v[220:223], v[116:119], v[156:159], v[220:223]
    ds_read_b64_tr_b16 v[184:185], v28 offset:28672
    ds_read_b64_tr_b16 v[186:187], v28 offset:30720
    s_waitcnt lgkmcnt(12)
    v_mfma_f32_16x16x32_bf16 v[208:211], v[120:123], v[160:163], v[208:211]
    ds_read_b64_tr_b16 v[188:189], v29 offset:28672
    ds_read_b64_tr_b16 v[190:191], v29 offset:30720
    s_waitcnt lgkmcnt(12)
    v_mfma_f32_16x16x32_bf16 v[212:215], v[120:123], v[164:167], v[212:215]
    s_waitcnt lgkmcnt(10)
    v_mfma_f32_16x16x32_bf16 v[216:219], v[120:123], v[168:171], v[216:219]
    s_waitcnt lgkmcnt(8)
    v_mfma_f32_16x16x32_bf16 v[220:223], v[120:123], v[172:175], v[220:223]
    s_waitcnt lgkmcnt(6)
    v_mfma_f32_16x16x32_bf16 v[208:211], v[124:127], v[176:179], v[208:211]
    s_waitcnt lgkmcnt(4)
    v_mfma_f32_16x16x32_bf16 v[212:215], v[124:127], v[180:183], v[212:215]
    s_waitcnt lgkmcnt(2)
    v_mfma_f32_16x16x32_bf16 v[216:219], v[124:127], v[184:187], v[216:219]
    s_waitcnt lgkmcnt(0)
    v_mfma_f32_16x16x32_bf16 v[220:223], v[124:127], v[188:191], v[220:223]
    s_waitcnt vmcnt(0)
    s_add_u32 s55, s55, 4
    v_mov_b32 v19, 1
    s_mov_b64 exec, 1
    ds_add_u32 v25, v19 offset:28
    s_mov_b64 exec, -1
    ds_read_b32 v19, v25 offset:28
    s_waitcnt lgkmcnt(0)
    v_readfirstlane_b32 s43, v19
    s_cmp_lt_u32 s43, s55
    s_cbranch_scc1 L_gs21
L_gx21:
    ds_read_b64_tr_b16 v[128:129], v16 offset:0
    ds_read_b64_tr_b16 v[130:131], v16 offset:2048
    ds_read_b64_tr_b16 v[132:133], v17 offset:0
    ds_read_b64_tr_b16 v[134:135], v17 offset:2048
    ds_read_b64_tr_b16 v[136:137], v18 offset:0
    ds_read_b64_tr_b16 v[138:139], v18 offset:2048
    ds_read_b64_tr_b16 v[140:141], v7 offset:0
    ds_read_b64_tr_b16 v[142:143], v7 offset:2048
    ds_read_b64_tr_b16 v[144:145], v16 offset:4096
    ds_read_b64_tr_b16 v[146:147], v16 offset:6144
    ds_read_b64_tr_b16 v[148:149], v17 offset:4096
    ds_read_b64_tr_b16 v[150:151], v17 offset:6144
    ds_read_b64_tr_b16 v[152:153], v18 offset:4096
    ds_read_b64_tr_b16 v[154:155], v18 offset:6144
    s_waitcnt lgkmcnt(12)
    v_mfma_f32_16x16x32_bf16 v[208:211], v[64:67], v[128:131], v[208:211]
    ds_read_b64_tr_b16 v[156:157], v7 offset:4096
    ds_read_b64_tr_b16 v[158:159], v7 offset:6144
    s_waitcnt lgkmcnt(12)
    v_mfma_f32_16x16x32_bf16 v[212:215], v[64:67], v[132:135], v[212:215]
    ds_read_b64_tr_b16 v[160:161], v16 offset:8192
    ds_read_b64_tr_b16 v[162:163], v16 offset:10240
    s_waitcnt lgkmcnt(12)
    v_mfma_f32_16x16x32_bf16 v[216:219], v[64:67], v[136:139], v[216:219]
    ds_read_b64_tr_b16 v[164:165], v17 offset:8192
    ds_read_b64_tr_b16 v[166:167], v17 offset:10240
    s_waitcnt lgkmcnt(12)
    v_mfma_f32_16x16x32_bf16 v[220:223], v[64:67], v[140:143], v[220:223]
    ds_read_b64_tr_b16 v[168:169], v18 offset:8192
    ds_read_b64_tr_b16 v[170:171], v18 offset:10240
    s_waitcnt lgkmcnt(12)
    v_mfma_f32_16x16x32_bf16 v[208:211], v[68:71], v[144:147], v[208:211]
    ds_read_b64_tr_b16 v[172:173], v7 offset:8192
    ds_read_b64_tr_b16 v[174:175], v7 offset:10240
    s_waitcnt lgkmcnt(12)
    v_mfma_f32_16x16x32_bf16 v[212:215], v[68:71], v[148:151], v[212:215]
    ds_read_b64_tr_b16 v[176:177], v16 offset:12288
    ds_read_b64_tr_b16 v[178:179], v16 offset:14336
    s_waitcnt lgkmcnt(12)
    v_mfma_f32_16x16x32_bf16 v[216:219], v[68:71], v[152:155], v[216:219]
    ds_read_b64_tr_b16 v[180:181], v17 offset:12288
    ds_read_b64_tr_b16 v[182:183], v17 offset:14336
    s_waitcnt lgkmcnt(12)
    v_mfma_f32_16x16x32_bf16 v[220:223], v[68:71], v[156:159], v[220:223]
    ds_read_b64_tr_b16 v[184:185], v18 offset:12288
    ds_read_b64_tr_b16 v[186:187], v18 offset:14336
    s_waitcnt lgkmcnt(12)
    v_mfma_f32_16x16x32_bf16 v[208:211], v[72:75], v[160:163], v[208:211]
    ds_read_b64_tr_b16 v[188:189], v7 offset:12288
    ds_read_b64_tr_b16 v[190:191], v7 offset:14336
    s_waitcnt lgkmcnt(12)
    v_mfma_f32_16x16x32_bf16 v[212:215], v[72:75], v[164:167], v[212:215]
    ds_read_b64_tr_b16 v[128:129], v16 offset:16384
    ds_read_b64_tr_b16 v[130:131], v16 offset:18432
    s_waitcnt lgkmcnt(12)
    v_mfma_f32_16x16x32_bf16 v[216:219], v[72:75], v[168:171], v[216:219]
    ds_read_b64_tr_b16 v[132:133], v17 offset:16384
    ds_read_b64_tr_b16 v[134:135], v17 offset:18432
    s_waitcnt lgkmcnt(12)
    v_mfma_f32_16x16x32_bf16 v[220:223], v[72:75], v[172:175], v[220:223]
    ds_read_b64_tr_b16 v[136:137], v18 offset:16384
    ds_read_b64_tr_b16 v[138:139], v18 offset:18432
    s_waitcnt lgkmcnt(12)
    v_mfma_f32_16x16x32_bf16 v[208:211], v[76:79], v[176:179], v[208:211]
    ds_read_b64_tr_b16 v[140:141], v7 offset:16384
    ds_read_b64_tr_b16 v[142:143], v7 offset:18432
    s_waitcnt lgkmcnt(12)
    v_mfma_f32_16x16x32_bf16 v[212:215], v[76:79], v[180:183], v[212:215]
    ds_read_b64_tr_b16 v[144:145], v16 offset:20480
    ds_read_b64_tr_b16 v[146:147], v16 offset:22528
    s_waitcnt lgkmcnt(12)
    v_mfma_f32_16x16x32_bf16 v[216:219], v[76:79], v[184:187], v[216:219]
    ds_read_b64_tr_b16 v[148:149], v17 offset:20480
    ds_read_b64_tr_b16 v[150:151], v17 offset:22528
    s_waitcnt lgkmcnt(12)
    v_mfma_f32_16x16x32_bf16 v[220:223], v[76:79], v[188:191], v[220:223]
    ds_read_b64_tr_b16 v[152:153], v18 offset:20480
    ds_read_b64_tr_b16 v[154:155], v18 offset:22528
    s_waitcnt lgkmcnt(12)
    v_mfma_f32_16x16x32_bf16 v[208:211], v[80:83], v[128:131], v[208:211]
    ds_read_b64_tr_b16 v[156:157], v7 offset:20480
    ds_read_b64_tr_b16 v[158:159], v7 offset:22528
    s_waitcnt lgkmcnt(12)
    v_mfma_f32_16x16x32_bf16 v[212:215], v[80:83], v[132:135], v[212:215]
    ds_read_b64_tr_b16 v[160:161], v16 offset:24576
    ds_read_b64_tr_b16 v[162:163], v16 offset:26624
    s_waitcnt lgkmcnt(12)
    v_mfma_f32_16x16x32_bf16 v[216:219], v[80:83], v[136:139], v[216:219]
    ds_read_b64_tr_b16 v[164:165], v17 offset:24576
    ds_read_b64_tr_b16 v[166:167], v17 offset:26624
    s_waitcnt lgkmcnt(12)
    v_mfma_f32_16x16x32_bf16 v[220:223], v[80:83], v[140:143], v[220:223]
    ds_read_b64_tr_b16 v[168:169], v18 offset:24576
    ds_read_b64_tr_b16 v[170:171], v18 offset:26624
    s_waitcnt lgkmcnt(12)
    v_mfma_f32_16x16x32_bf16 v[208:211], v[84:87], v[144:147], v[208:211]
    ds_read_b64_tr_b16 v[172:173], v7 offset:24576
    ds_read_b64_tr_b16 v[174:175], v7 offset:26624
    s_waitcnt lgkmcnt(12)
    v_mfma_f32_16x16x32_bf16 v[212:215], v[84:87], v[148:151], v[212:215]
    ds_read_b64_tr_b16 v[176:177], v16 offset:28672
    ds_read_b64_tr_b16 v[178:179], v16 offset:30720
    s_waitcnt lgkmcnt(12)
    v_mfma_f32_16x16x32_bf16 v[216:219], v[84:87], v[152:155], v[216:219]
    ds_read_b64_tr_b16 v[180:181], v17 offset:28672
    ds_read_b64_tr_b16 v[182:183], v17 offset:30720
    s_waitcnt lgkmcnt(12)
    v_mfma_f32_16x16x32_bf16 v[220:223], v[84:87], v[156:159], v[220:223]
    ds_read_b64_tr_b16 v[184:185], v18 offset:28672
    ds_read_b64_tr_b16 v[186:187], v18 offset:30720
    s_waitcnt lgkmcnt(12)
    v_mfma_f32_16x16x32_bf16 v[208:211], v[88:91], v[160:163], v[208:211]
    ds_read_b64_tr_b16 v[188:189], v7 offset:28672
    ds_read_b64_tr_b16 v[190:191], v7 offset:30720
    s_waitcnt lgkmcnt(12)
    v_mfma_f32_16x16x32_bf16 v[212:215], v[88:91], v[164:167], v[212:215]
    s_waitcnt lgkmcnt(10)
    v_mfma_f32_16x16x32_bf16 v[216:219], v[88:91], v[168:171], v[216:219]
    s_waitcnt lgkmcnt(8)
    v_mfma_f32_16x16x32_bf16 v[220:223], v[88:91], v[172:175], v[220:223]
    s_waitcnt lgkmcnt(6)
    v_mfma_f32_16x16x32_bf16 v[208:211], v[92:95], v[176:179], v[208:211]
    s_waitcnt lgkmcnt(4)
    v_mfma_f32_16x16x32_bf16 v[212:215], v[92:95], v[180:183], v[212:215]
    s_waitcnt lgkmcnt(2)
    v_mfma_f32_16x16x32_bf16 v[216:219], v[92:95], v[184:187], v[216:219]
    s_waitcnt lgkmcnt(0)
    v_mfma_f32_16x16x32_bf16 v[220:223], v[92:95], v[188:191], v[220:223]
    s_nop 7
    ds_write_b128 v20, v[208:211] offset:0
    ds_write_b128 v20, v[212:215] offset:4096
    ds_write_b128 v20, v[216:219] offset:8192
    ds_write_b128 v20, v[220:223] offset:12288
    s_branch L_final
L_gs0:
    s_mov_b32 s49, 0x400000
L_gb0:
    s_sub_u32 s49, s49, 1
    s_cbranch_scc1 L_gx0
    s_sleep 1
    ds_read_b32 v19, v25 offset:0
    s_waitcnt lgkmcnt(0)
    v_readfirstlane_b32 s43, v19
    s_cmp_lt_u32 s43, 4
    s_cbranch_scc1 L_gb0
    s_branch L_gx0
L_gs1:
    s_mov_b32 s49, 0x400000
L_gb1:
    s_sub_u32 s49, s49, 1
    s_cbranch_scc1 L_gx1
    s_sleep 1
    ds_read_b32 v19, v25 offset:44
    s_waitcnt lgkmcnt(0)
    v_readfirstlane_b32 s43, v19
    s_cmp_lt_u32 s43, 4
    s_cbranch_scc1 L_gb1
    s_branch L_gx1
L_gs2:
    s_mov_b32 s49, 0x400000
L_gb2:
    s_sub_u32 s49, s49, 1
    s_cbranch_scc1 L_gx2
    s_sleep 1
    ds_read_b32 v19, v25 offset:8
    s_waitcnt lgkmcnt(0)
    v_readfirstlane_b32 s43, v19
    s_cmp_lt_u32 s43, 4
    s_cbranch_scc1 L_gb2
    s_branch L_gx2
L_gs3:
    s_mov_b32 s49, 0x400000
L_gb3:
    s_sub_u32 s49, s49, 1
    s_cbranch_scc1 L_gx3
    s_sleep 1
    ds_read_b32 v19, v25 offset:4
    s_waitcnt lgkmcnt(0)
    v_readfirstlane_b32 s43, v19
    s_cmp_lt_u32 s43, 4
    s_cbranch_scc1 L_gb3
    s_branch L_gx3
L_gs4:
    s_mov_b32 s49, 0x400000
L_gb4:
    s_sub_u32 s49, s49, 1
    s_cbranch_scc1 L_gx4
    s_sleep 1
    ds_read_b32 v19, v25 offset:12
    s_waitcnt lgkmcnt(0)
    v_readfirstlane_b32 s43, v19
    s_cmp_lt_u32 s43, 4
    s_cbranch_scc1 L_gb4
    s_branch L_gx4
L_gs5:
    s_mov_b32 s49, 0x400000
L_gb5:
    s_sub_u32 s49, s49, 1
    s_cbranch_scc1 L_gx5
    s_sleep 1
    ds_read_b32 v19, v25 offset:48
    s_waitcnt lgkmcnt(0)
    v_readfirstlane_b32 s43, v19
    s_cmp_lt_u32 s43, 4
    s_cbranch_scc1 L_gb5
    s_branch L_gx5
L_gs6:
    s_mov_b32 s49, 0x400000
L_gb6:
    s_sub_u32 s49, s49, 1
    s_cbranch_scc1 L_gx6
    s_sleep 1
    ds_read_b32 v19, v25 offset:52
    s_waitcnt lgkmcnt(0)
    v_readfirstlane_b32 s43, v19
    s_cmp_lt_u32 s43, 4
    s_cbranch_scc1 L_gb6
    s_branch L_gx6
L_slow0:
    s_waitcnt vmcnt(0)
    s_mov_b64 exec, 1
    buffer_store_dword v5, off, s[36:39], s60 sc1
    s_mov_b64 exec, -1
    s_mov_b32 s49, 0
L_spin0:
    s_sleep 8
    s_mov_b64 exec, vcc
    buffer_load_dword v31, v106, s[36:39], s62 offen sc1
    s_mov_b64 exec, -1
    s_waitcnt vmcnt(0)
    v_cmp_ne_u32 vcc, v31, v5
    s_cmp_lg_u64 vcc, 0
    s_cbranch_scc0 L_back0
    s_add_u32 s49, s49, 1
    s_cmp_lt_u32 s49, 0x40000
    s_cbranch_scc1 L_spin0
    s_branch L_back0
L_gs7:
    s_mov_b32 s49, 0x400000
L_gb7:
    s_sub_u32 s49, s49, 1
    s_cbranch_scc1 L_gx7
    s_sleep 1
    ds_read_b32 v19, v25 offset:32
    s_waitcnt lgkmcnt(0)
    v_readfirstlane_b32 s43, v19
    s_cmp_lt_u32 s43, 4
    s_cbranch_scc1 L_gb7
    s_branch L_gx7
L_gs8:
    s_mov_b32 s49, 0x400000
L_gb8:
    s_sub_u32 s49, s49, 1
    s_cbranch_scc1 L_gx8
    s_sleep 1
    ds_read_b32 v19, v25 offset:16
    s_waitcnt lgkmcnt(0)
    v_readfirstlane_b32 s43, v19
    s_cmp_lt_u32 s43, 4
    s_cbranch_scc1 L_gb8
    s_branch L_gx8
L_slow1:
    s_mov_b32 s49, 0
L_spin1:
    s_sleep 8
    s_mov_b64 exec, vcc
    buffer_load_dword v31, v106, s[36:39], s62 offen sc1
    s_mov_b64 exec, -1
    s_waitcnt vmcnt(0)
    v_cmp_ne_u32 vcc, v31, v5
    s_cmp_lg_u64 vcc, 0
    s_cbranch_scc0 L_back1
    s_add_u32 s49, s49, 1
    s_cmp_lt_u32 s49, 0x40000
    s_cbranch_scc1 L_spin1
    s_branch L_back1
L_gs9:
    s_mov_b32 s49, 0x400000
L_gb9:
    s_sub_u32 s49, s49, 1
    s_cbranch_scc1 L_gx9
    s_sleep 1
    ds_read_b32 v19, v25 offset:36
    s_waitcnt lgkmcnt(0)
    v_readfirstlane_b32 s43, v19
    s_cmp_lt_u32 s43, 4
    s_cbranch_scc1 L_gb9
    s_branch L_gx9
L_gs10:
    s_mov_b32 s49, 0x400000
L_gb10:
    s_sub_u32 s49, s49, 1
    s_cbranch_scc1 L_gx10
    s_sleep 1
    ds_read_b32 v19, v25 offset:40
    s_waitcnt lgkmcnt(0)
    v_readfirstlane_b32 s43, v19
    s_cmp_lt_u32 s43, 4
    s_cbranch_scc1 L_gb10
    s_branch L_gx10
L_yxs:
    s_add_u32 s49, s49, 1
    s_cmp_lt_u32 s49, 0x40000
    s_cbranch_scc0 L_yxb
    s_sleep 6
    s_branch L_yx
L_gs11:
    s_mov_b32 s49, 0x400000
L_gb11:
    s_sub_u32 s49, s49, 1
    s_cbranch_scc1 L_gx11
    s_sleep 1
    ds_read_b32 v19, v25 offset:0
    s_waitcnt lgkmcnt(0)
    v_readfirstlane_b32 s43, v19
    s_cmp_lt_u32 s43, 4
    s_cbranch_scc1 L_gb11
    s_branch L_gx11
L_gs12:
    s_mov_b32 s49, 0x400000
L_gb12:
    s_sub_u32 s49, s49, 1
    s_cbranch_scc1 L_gx12
    s_sleep 1
    ds_read_b32 v19, v25 offset:8
    s_waitcnt lgkmcnt(0)
    v_readfirstlane_b32 s43, v19
    s_cmp_lt_u32 s43, 4
    s_cbranch_scc1 L_gb12
    s_branch L_gx12
L_gs13:
    s_mov_b32 s49, 0x400000
L_gb13:
    s_sub_u32 s49, s49, 1
    s_cbranch_scc1 L_gx13
    s_sleep 1
    ds_read_b32 v19, v25 offset:12
    s_waitcnt lgkmcnt(0)
    v_readfirstlane_b32 s43, v19
    s_cmp_lt_u32 s43, 4
    s_cbranch_scc1 L_gb13
    s_branch L_gx13
L_slow2:
    s_mov_b32 s49, 0
L_spin2:
    s_sleep 8
    s_mov_b64 exec, vcc
    buffer_load_dword v13, v14, s[36:39], s54 offen sc1
    s_mov_b64 exec, -1
    s_waitcnt vmcnt(0)
    v_cmp_ne_u32 vcc, v13, v5
    s_cmp_lg_u64 vcc, 0
    s_cbranch_scc0 L_back2
    s_add_u32 s49, s49, 1
    s_cmp_lt_u32 s49, 0x40000
    s_cbranch_scc1 L_spin2
    s_branch L_back2
L_gs14:
    s_mov_b32 s49, 0x400000
L_gb14:
    s_sub_u32 s49, s49, 1
    s_cbranch_scc1 L_gx14
    s_sleep 1
    ds_read_b32 v19, v25 offset:28
    s_waitcnt lgkmcnt(0)
    v_readfirstlane_b32 s43, v19
    s_cmp_lt_u32 s43, s55
    s_cbranch_scc1 L_gb14
    s_branch L_gx14
L_creal:
    s_cmp_eq_u32 s50, 0
    s_cbranch_scc1 L_c0
    v_mov_b32 v32, v48
    v_mov_b32 v33, v49
    v_mov_b32 v34, v50
    v_mov_b32 v35, v51
    v_mov_b32 v36, v52
    v_mov_b32 v37, v53
    v_mov_b32 v38, v54
    v_mov_b32 v39, v55
    v_mov_b32 v40, v56
    v_mov_b32 v41, v57
    v_mov_b32 v42, v58
    v_mov_b32 v43, v59
    v_mov_b32 v44, v60
    v_mov_b32 v45, v61
    v_mov_b32 v46, v62
    v_mov_b32 v47, v63
L_c0:
    v_mov_b32 v48, 0
    v_mov_b32 v49, 0
    v_mov_b32 v50, 0
    v_mov_b32 v51, 0
    v_mov_b32 v52, 0
    v_mov_b32 v53, 0
    v_mov_b32 v54, 0
    v_mov_b32 v55, 0
    v_mov_b32 v56, 0
    v_mov_b32 v57, 0
    v_mov_b32 v58, 0
    v_mov_b32 v59, 0
    v_mov_b32 v60, 0
    v_mov_b32 v61, 0
    v_mov_b32 v62, 0
    v_mov_b32 v63, 0
    s_nop 1
    s_branch L_cplx
L_gs15:
    s_mov_b32 s49, 0x400000
L_gb15:
    s_sub_u32 s49, s49, 1
    s_cbranch_scc1 L_gx15
    s_sleep 1
    ds_read_b32 v19, v25 offset:28
    s_waitcnt lgkmcnt(0)
    v_readfirstlane_b32 s43, v19
    s_cmp_lt_u32 s43, s55
    s_cbranch_scc1 L_gb15
    s_branch L_gx15
L_gs16:
    s_mov_b32 s49, 0x400000
L_gb16:
    s_sub_u32 s49, s49, 1
    s_cbranch_scc1 L_gx16
    s_sleep 1
    ds_read_b32 v19, v25 offset:28
    s_waitcnt lgkmcnt(0)
    v_readfirstlane_b32 s43, v19
    s_cmp_lt_u32 s43, s55
    s_cbranch_scc1 L_gb16
    s_branch L_gx16
L_csecond:
    s_mov_b32 s50, 1
    s_add_u32 s51, s51, 4096
    v_mov_b32 v232, v240
    v_mov_b32 v233, v241
    v_mov_b32 v234, v242
    v_mov_b32 v235, v243
    v_mov_b32 v236, v244
    v_mov_b32 v237, v245
    v_mov_b32 v238, v246
    v_mov_b32 v239, v247
    s_add_u32 s55, s55, 4
    v_mov_b32 v19, 1
    s_mov_b64 exec, 1
    ds_add_u32 v25, v19 offset:28
    s_mov_b64 exec, -1
    ds_read_b32 v19, v25 offset:28
    s_waitcnt lgkmcnt(0)
    v_readfirstlane_b32 s43, v19
    s_cmp_lt_u32 s43, s55
    s_cbranch_scc1 L_gs16
L_gx16:
    s_branch L_ccol
L_gs17:
    s_mov_b32 s49, 0x400000
L_gb17:
    s_sub_u32 s49, s49, 1
    s_cbranch_scc1 L_gx17
    s_sleep 1
    ds_read_b32 v19, v25 offset:28
    s_waitcnt lgkmcnt(0)
    v_readfirstlane_b32 s43, v19
    s_cmp_lt_u32 s43, s55
    s_cbranch_scc1 L_gb17
    s_branch L_gx17
L_gs18:
    s_mov_b32 s49, 0x400000
L_gb18:
    s_sub_u32 s49, s49, 1
    s_cbranch_scc1 L_gx18
    s_sleep 4
    ds_read_b32 v19, v25 offset:20
    s_waitcnt lgkmcnt(0)
    v_readfirstlane_b32 s43, v19
    s_cmp_lt_u32 s43, 4
    s_cbranch_scc1 L_gb18
    s_branch L_gx18
L_slow3:
    s_mov_b32 s49, 0
L_spin3:
    s_sleep 8
    s_mov_b64 exec, vcc
    buffer_load_dword v30, v15, s[36:39], s54 offen sc1
    s_mov_b64 exec, -1
    s_waitcnt vmcnt(0)
    v_cmp_ne_u32 vcc, v30, v5
    s_cmp_lg_u64 vcc, 0
    s_cbranch_scc0 L_back3
    s_add_u32 s49, s49, 1
    s_cmp_lt_u32 s49, 0x40000
    s_cbranch_scc1 L_spin3
    s_branch L_back3
L_gs19:
    s_mov_b32 s49, 0x400000
L_gb19:
    s_sub_u32 s49, s49, 1
    s_cbranch_scc1 L_gx19
    s_sleep 4
    ds_read_b32 v19, v25 offset:24
    s_waitcnt lgkmcnt(0)
    v_readfirstlane_b32 s43, v19
    s_cmp_lt_u32 s43, 4
    s_cbranch_scc1 L_gb19
    s_branch L_gx19
L_slow4:
    s_mov_b32 s49, 0
L_spin4:
    s_sleep 8
    s_mov_b64 exec, vcc
    buffer_load_dword v30, v15, s[36:39], s54 offen sc1
    s_mov_b64 exec, -1
    s_waitcnt vmcnt(0)
    v_cmp_ne_u32 vcc, v30, v5
    s_cmp_lg_u64 vcc, 0
    s_cbranch_scc0 L_back4
    s_add_u32 s49, s49, 1
    s_cmp_lt_u32 s49, 0x40000
    s_cbranch_scc1 L_spin4
    s_branch L_back4
L_gs20:
    s_mov_b32 s49, 0x400000
L_gb20:
    s_sub_u32 s49, s49, 1
    s_cbranch_scc1 L_gx20
    s_sleep 1
    ds_read_b32 v19, v25 offset:28
    s_waitcnt lgkmcnt(0)
    v_readfirstlane_b32 s43, v19
    s_cmp_lt_u32 s43, s55
    s_cbranch_scc1 L_gb20
    s_branch L_gx20
L_gs21:
    s_mov_b32 s49, 0x400000
L_gb21:
    s_sub_u32 s49, s49, 1
    s_cbranch_scc1 L_gx21
    s_sleep 1
    ds_read_b32 v19, v25 offset:28
    s_waitcnt lgkmcnt(0)
    v_readfirstlane_b32 s43, v19
    s_cmp_lt_u32 s43, s55
    s_cbranch_scc1 L_gb21
    s_branch L_gx21
L_end:
.section .rodata,"a"
.p2align 6
.amdhsa_kernel recurrent_scan__spectral_gfnet__dense_activation_relu__prompt_kernel
  .amdhsa_next_free_vgpr 256
  .amdhsa_next_free_sgpr 64
  .amdhsa_accum_offset 256
  .amdhsa_group_segment_fixed_size 0
  .amdhsa_kernarg_size 72
  .amdhsa_user_sgpr_count 2
  .amdhsa_user_sgpr_kernarg_segment_ptr 1
  .amdhsa_system_sgpr_workgroup_id_x 1
  .amdhsa_float_denorm_mode_32 3
.end_amdhsa_kernel
```
